```python
import torch

def _softmax(x, axis=-1):
    return torch.softmax(x, dim=axis)
def _gelu(x):
    return torch.nn.functional.gelu(x, approximate="tanh")
def _silu(x):
    return torch.nn.functional.silu(x)
def _sigmoid(x):
    return torch.sigmoid(x)
def _layernorm(x, axis=-1, eps=1e-5):
    m = x.mean(dim=axis, keepdim=True)
    v = x.var(dim=axis, keepdim=True, unbiased=False)
    return (x - m) / torch.sqrt(v + eps)
def _scatter_add(tgt, idx, src, axis=0):
    return tgt.clone().index_add_(axis, idx, src)
def _segment_sum(src, seg, n):
    out = torch.zeros((n,) + src.shape[1:], dtype=src.dtype)
    return out.index_add_(0, seg, src)
def _pad(x, pw):
    flat = tuple(v for pair in reversed(pw) for v in pair)
    return torch.nn.functional.pad(x, flat)

kernel_name = 'concat_heads__mha_block_cached__mha_block_cached__near_ridge'

def setup_inputs():

    _w = (lambda a: (lambda t: t.to(torch.bfloat16) if t.is_floating_point() else t)(torch.as_tensor(a)))
    def _A_setup():
        B, Sq, D = 8, 128, 640
        H, Sk, Dh = 32, 512, 192
        return {
            "x": _w((lambda *s: torch.randn(*s, dtype=torch.bfloat16) * 0.8)(B, Sq, D)),
            "k_cache": _w((lambda *s: torch.randn(*s, dtype=torch.bfloat16) * 0.8)(B, H, Sk, Dh)),
            "v_cache": _w((lambda *s: torch.randn(*s, dtype=torch.bfloat16) * 0.05)(B, H, Sk, Dh)),
            "wq": _w((lambda *s: torch.randn(*s, dtype=torch.bfloat16) * 0.8)(D, H * Dh) * (D ** -0.5)),
            "wo": _w((lambda *s: torch.randn(*s, dtype=torch.bfloat16) * 0.05)(H * Dh, D) * ((H * Dh) ** -0.5)),
        }
    _A_in = _A_setup()

    def _B_setup():
        B, Sq, D = 8, 128, 640
        H, Sk, Dh = 32, 512, 192
        return {
            "x": _w((lambda *s: torch.randn(*s, dtype=torch.bfloat16) * 0.8)(B, Sq, D)),
            "k_cache": _w((lambda *s: torch.randn(*s, dtype=torch.bfloat16) * 0.8)(B, H, Sk, Dh)),
            "v_cache": _w((lambda *s: torch.randn(*s, dtype=torch.bfloat16) * 0.05)(B, H, Sk, Dh)),
            "wq": _w((lambda *s: torch.randn(*s, dtype=torch.bfloat16) * 0.8)(D, H * Dh) * (D ** -0.5)),
            "wo": _w((lambda *s: torch.randn(*s, dtype=torch.bfloat16) * 0.05)(H * Dh, D) * ((H * Dh) ** -0.5)),
        }
    _B_in = _B_setup()

    return {
        "A_x": _A_in["x"],
        "A_k_cache": _A_in["k_cache"],
        "A_v_cache": _A_in["v_cache"],
        "A_wq": _A_in["wq"],
        "A_wo": _A_in["wo"],
        "B_x": _B_in["x"],
        "B_k_cache": _B_in["k_cache"],
        "B_v_cache": _B_in["v_cache"],
        "B_wq": _B_in["wq"],
        "B_wo": _B_in["wo"],
    }

def reference(A_x, A_k_cache, A_v_cache, A_wq, A_wo, B_x, B_k_cache, B_v_cache, B_wq, B_wo):
    def _A_ref(x, k_cache, v_cache, wq, wo):
        B, Sq, D = x.shape
        H, Dh = 32, 192
        q = (lambda x, *d: x.permute(*d))((x @ wq).reshape(B, Sq, H, Dh), 0, 2, 1, 3)
        scores = torch.einsum("bhqd,bhkd->bhqk", q, k_cache) * (Dh ** -0.5)
        p = _softmax(scores, axis=-1)
        o = torch.einsum("bhqk,bhkd->bhqd", p, v_cache)
        return (lambda x, *d: x.permute(*d))(o, 0, 2, 1, 3).reshape(B, Sq, H * Dh) @ wo

    def _B_ref(x, k_cache, v_cache, wq, wo):
        B, Sq, D = x.shape
        H, Dh = 32, 192
        q = (lambda x, *d: x.permute(*d))((x @ wq).reshape(B, Sq, H, Dh), 0, 2, 1, 3)
        scores = torch.einsum("bhqd,bhkd->bhqk", q, k_cache) * (Dh ** -0.5)
        p = _softmax(scores, axis=-1)
        o = torch.einsum("bhqk,bhkd->bhqd", p, v_cache)
        return (lambda x, *d: x.permute(*d))(o, 0, 2, 1, 3).reshape(B, Sq, H * Dh) @ wo

    a = _A_ref(A_x, A_k_cache, A_v_cache, A_wq, A_wo)
    b = _B_ref(B_x, B_k_cache, B_v_cache, B_wq, B_wo)
    return torch.concatenate([a, b], axis=-1)
```

```asm
; @launch kernel=attn_kernel grid=(512,1,1) block=(256,1,1) lds=81920
; @launch kernel=oproj_kernel grid=(256,1,1) block=(256,1,1) lds=147456
; @launch kernel=reduce_kernel grid=(640,1,1) block=(256,1,1) lds=0
.amdgcn_target "amdgcn-amd-amdhsa--gfx950"
.text
.globl attn_kernel
.p2align 8
.type attn_kernel,@function
attn_kernel:
    s_cmp_ge_u32 s2, 512
    s_cbranch_scc1 attn_exit
    s_load_dwordx16 s[4:19], s[0:1], 0
    s_load_dwordx4 s[20:23], s[0:1], 64
    s_load_dwordx2 s[24:25], s[0:1], 96
    s_load_dwordx2 s[26:27], s[0:1], 88
    v_lshrrev_b32 v1, 6, v0
    s_nop 1
    v_readfirstlane_b32 s48, v1
    v_and_b32 v0, 63, v0
    s_and_b32 s58, s2, 1
    s_bfe_u32 s52, s2, 0x20001
    s_bfe_u32 s60, s2, 0x30003
    s_lshr_b32 s56, s2, 6
    s_lshl_b32 s52, s52, 3
    s_add_u32 s57, s52, s60
    s_mul_i32 s49, s48, 6144
    s_mul_i32 s50, s48, 3072
    s_lshl_b32 s51, s48, 12
    s_add_u32 s51, s51, 49152
    v_lshrrev_b32 v40, 3, v0
    v_and_b32 v41, 7, v0
    s_lshl_b32 s52, s48, 3
    v_mov_b32 v42, v40
    v_mul_u32_u24 v43, 0x5556, v42
    v_lshrrev_b32 v43, 16, v43
    v_mul_u32_u24 v46, 3, v43
    v_sub_u32 v46, v42, v46
    v_add_u32 v43, s52, v43
    v_bfe_u32 v44, v43, 1, 1
    v_lshlrev_b32 v44, 2, v44
    v_bfe_u32 v45, v43, 3, 1
    v_lshl_or_b32 v44, v45, 1, v44
    v_bfe_u32 v45, v43, 2, 1
    v_or_b32 v44, v45, v44
    v_xor_b32 v44, v44, v41
    v_lshlrev_b32 v44, 4, v44
    v_lshl_add_u32 v44, v46, 7, v44
    v_mul_u32_u24 v43, 0x3000, v43
    v_add_u32 v7, v43, v44
    v_add_u32 v42, 8, v40
    v_mul_u32_u24 v43, 0x5556, v42
    v_lshrrev_b32 v43, 16, v43
    v_mul_u32_u24 v46, 3, v43
    v_sub_u32 v46, v42, v46
    v_add_u32 v43, s52, v43
    v_bfe_u32 v44, v43, 1, 1
    v_lshlrev_b32 v44, 2, v44
    v_bfe_u32 v45, v43, 3, 1
    v_lshl_or_b32 v44, v45, 1, v44
    v_bfe_u32 v45, v43, 2, 1
    v_or_b32 v44, v45, v44
    v_xor_b32 v44, v44, v41
    v_lshlrev_b32 v44, 4, v44
    v_lshl_add_u32 v44, v46, 7, v44
    v_mul_u32_u24 v43, 0x3000, v43
    v_add_u32 v44, v43, v44
    v_subrev_u32 v8, 1024, v44
    v_add_u32 v42, 16, v40
    v_mul_u32_u24 v43, 0x5556, v42
    v_lshrrev_b32 v43, 16, v43
    v_mul_u32_u24 v46, 3, v43
    v_sub_u32 v46, v42, v46
    v_add_u32 v43, s52, v43
    v_bfe_u32 v44, v43, 1, 1
    v_lshlrev_b32 v44, 2, v44
    v_bfe_u32 v45, v43, 3, 1
    v_lshl_or_b32 v44, v45, 1, v44
    v_bfe_u32 v45, v43, 2, 1
    v_or_b32 v44, v45, v44
    v_xor_b32 v44, v44, v41
    v_lshlrev_b32 v44, 4, v44
    v_lshl_add_u32 v44, v46, 7, v44
    v_mul_u32_u24 v43, 0x3000, v43
    v_add_u32 v44, v43, v44
    v_subrev_u32 v9, 2048, v44
    s_lshl_b32 s52, s48, 5
    v_lshrrev_b32 v42, 4, v0
    v_xor_b32 v43, v42, v41
    v_lshlrev_b32 v43, 4, v43
    v_add_u32 v44, s52, v40
    v_mul_u32_u24 v44, 0x500, v44
    v_add_u32 v10, v44, v43
    v_xor_b32 v43, 64, v43
    v_add_u32 v44, 9216, v44
    v_add_u32 v11, v44, v43
    s_waitcnt lgkmcnt(0)
    s_cmp_eq_u32 s58, 0
    s_cselect_b32 s4, s4, s14
    s_cselect_b32 s5, s5, s15
    s_cselect_b32 s6, s6, s16
    s_cselect_b32 s7, s7, s17
    s_cselect_b32 s8, s8, s18
    s_cselect_b32 s9, s9, s19
    s_cselect_b32 s10, s10, s20
    s_cselect_b32 s11, s11, s21
    s_cselect_b32 s12, s12, s22
    s_cselect_b32 s13, s13, s23
    s_mul_i32 s52, s57, 384
    s_add_u32 s10, s10, s52
    s_addc_u32 s11, s11, 0
    s_sub_u32 s53, 7864320, s52
    s_mov_b32 s32, s10
    s_and_b32 s33, s11, 0xffff
    s_mov_b32 s34, s53
    s_mov_b32 s35, 0x00020000
    s_mul_i32 s52, s56, 163840
    s_add_u32 s4, s4, s52
    s_addc_u32 s5, s5, 0
    s_mov_b32 s28, s4
    s_and_b32 s29, s5, 0xffff
    s_mov_b32 s30, 163840
    s_mov_b32 s31, 0x00020000
    s_mov_b32 s53, 0
    s_mov_b32 s54, 0
    s_add_u32 m0, s51, 0
    s_add_u32 s65, s54, 18432
    buffer_load_dwordx4 v10, s[28:31], s54 offen lds
    buffer_load_dwordx4 v11, s[28:31], s54 offen offset:1024 lds
    buffer_load_dwordx4 v10, s[28:31], s65 offen offset:2048 lds
    buffer_load_dwordx4 v11, s[28:31], s65 offen offset:3072 lds
    s_add_u32 s54, s54, 128
    s_add_u32 m0, s50, 0
    s_nop 0
    buffer_load_dwordx4 v7, s[32:35], s53 offen lds
    buffer_load_dwordx4 v8, s[32:35], s53 offen offset:1024 lds
    buffer_load_dwordx4 v9, s[32:35], s53 offen offset:2048 lds
    s_add_u32 s53, s53, 393216
    s_add_u32 m0, s50, 12288
    s_nop 0
    buffer_load_dwordx4 v7, s[32:35], s53 offen lds
    buffer_load_dwordx4 v8, s[32:35], s53 offen offset:1024 lds
    buffer_load_dwordx4 v9, s[32:35], s53 offen offset:2048 lds
    s_add_u32 s53, s53, 393216
    s_and_b32 s52, s2, 7
    s_lshl_b32 s52, s52, 5
    s_add_u32 s26, s26, s52
    s_addc_u32 s27, s27, 0
    s_mov_b32 s84, s26
    s_and_b32 s85, s27, 0xffff
    s_mov_b32 s86, 4
    s_mov_b32 s87, 0x00020000
    s_cmp_lt_u32 s56, 4
    s_cbranch_scc1 attn_lo
    v_min_u32 v40, 59, v0
    v_mul_u32_u24 v42, 0x5556, v40
    v_lshrrev_b32 v42, 16, v42
    v_mul_u32_u24 v43, 3, v42
    v_sub_u32 v43, v40, v43
    s_sub_u32 s69, s56, 4
    s_mul_i32 s52, s69, 80
    s_mul_i32 s59, s48, 20
    s_add_u32 s52, s52, s59
    v_add_u32 v42, s52, v42
    v_mul_u32_u24 v42, 0x3000, v42
    v_lshl_add_u32 v42, v43, 7, v42
    s_mov_b32 s52, 3932160
    s_sub_u32 s92, s4, 655360
    s_subb_u32 s93, s5, 0
    s_mov_b32 s88, s92
    s_and_b32 s89, s93, 0xffff
    s_mov_b32 s90, 819200
    s_mov_b32 s91, 0x00020000
    s_lshl_b32 s59, s60, 2
    s_add_u32 s59, s59, s48
    s_mul_i32 s59, s59, 5120
    v_mul_u32_u24 v43, 80, v0
    v_add_u32 v43, s59, v43
    buffer_load_dword v96, v43, s[28:31], 0 offen
    s_bfe_u32 s52, s2, 0x70001
    s_lshl_b32 s52, s52, 2
    s_add_u32 s52, s52, s48
    s_mul_i32 s52, s52, 15360
    v_min_u32 v40, 59, v0
    v_lshlrev_b32 v40, 7, v40
    v_add_u32 v40, s52, v40
    s_mov_b32 s88, s12
    s_and_b32 s89, s13, 0xffff
    s_mov_b32 s90, 7864320
    s_mov_b32 s91, 0x00020000
    s_mov_b32 s52, 7680
    buffer_load_dword v96, v40, s[88:91], 0 offen
    buffer_load_dword v96, v40, s[88:91], s52 offen
attn_lo:
    v_lshrrev_b32 v40, 3, v0
    s_lshl_b32 s52, s56, 5
    s_add_u32 s52, s52, s57
    s_mul_i32 s52, s52, 196608
    s_add_u32 s6, s6, s52
    s_addc_u32 s7, s7, 0
    s_add_u32 s8, s8, s52
    s_addc_u32 s9, s9, 0
    s_mov_b32 s36, s6
    s_and_b32 s37, s7, 0xffff
    s_mov_b32 s38, 196608
    s_mov_b32 s39, 0x00020000
    s_mov_b32 s40, s8
    s_and_b32 s41, s9, 0xffff
    s_mov_b32 s42, 196608
    s_mov_b32 s43, 0x00020000
    s_lshl_b32 s52, s58, 3
    s_add_u32 s52, s52, s56
    s_mul_i32 s52, s52, 96
    s_mul_i32 s59, s57, 3
    s_add_u32 s52, s52, s59
    s_lshl_b32 s52, s52, 14
    s_add_u32 s24, s24, s52
    s_addc_u32 s25, s25, 0
    s_mov_b32 s44, s24
    s_and_b32 s45, s25, 0xffff
    s_mov_b32 s46, 49152
    s_mov_b32 s47, 0x00020000
    s_mov_b32 s59, 0x3dd53b95
    v_mov_b32 v42, v40
    v_mul_u32_u24 v43, 0x5556, v42
    v_lshrrev_b32 v43, 16, v43
    v_bfe_u32 v44, v43, 1, 1
    v_lshlrev_b32 v44, 2, v44
    v_bfe_u32 v45, v43, 3, 1
    v_lshl_or_b32 v44, v45, 1, v44
    v_bfe_u32 v45, v43, 2, 1
    v_or_b32 v44, v45, v44
    v_xor_b32 v44, v44, v41
    v_lshlrev_b32 v44, 4, v44
    v_lshl_add_u32 v44, v40, 7, v44
    v_add_u32 v1, s49, v44
    v_add_u32 v42, 8, v40
    v_mul_u32_u24 v43, 0x5556, v42
    v_lshrrev_b32 v43, 16, v43
    v_bfe_u32 v44, v43, 1, 1
    v_lshlrev_b32 v44, 2, v44
    v_bfe_u32 v45, v43, 3, 1
    v_lshl_or_b32 v44, v45, 1, v44
    v_bfe_u32 v45, v43, 2, 1
    v_or_b32 v44, v45, v44
    v_xor_b32 v44, v44, v41
    v_lshlrev_b32 v44, 4, v44
    v_lshl_add_u32 v44, v40, 7, v44
    v_add_u32 v2, s49, v44
    v_add_u32 v42, 16, v40
    v_mul_u32_u24 v43, 0x5556, v42
    v_lshrrev_b32 v43, 16, v43
    v_bfe_u32 v44, v43, 1, 1
    v_lshlrev_b32 v44, 2, v44
    v_bfe_u32 v45, v43, 3, 1
    v_lshl_or_b32 v44, v45, 1, v44
    v_bfe_u32 v45, v43, 2, 1
    v_or_b32 v44, v45, v44
    v_xor_b32 v44, v44, v41
    v_lshlrev_b32 v44, 4, v44
    v_lshl_add_u32 v44, v40, 7, v44
    v_add_u32 v3, s49, v44
    v_add_u32 v42, 24, v40
    v_mul_u32_u24 v43, 0x5556, v42
    v_lshrrev_b32 v43, 16, v43
    v_bfe_u32 v44, v43, 1, 1
    v_lshlrev_b32 v44, 2, v44
    v_bfe_u32 v45, v43, 3, 1
    v_lshl_or_b32 v44, v45, 1, v44
    v_bfe_u32 v45, v43, 2, 1
    v_or_b32 v44, v45, v44
    v_xor_b32 v44, v44, v41
    v_lshlrev_b32 v44, 4, v44
    v_lshl_add_u32 v44, v40, 7, v44
    v_add_u32 v4, s49, v44
    v_add_u32 v42, 32, v40
    v_mul_u32_u24 v43, 0x5556, v42
    v_lshrrev_b32 v43, 16, v43
    v_bfe_u32 v44, v43, 1, 1
    v_lshlrev_b32 v44, 2, v44
    v_bfe_u32 v45, v43, 3, 1
    v_lshl_or_b32 v44, v45, 1, v44
    v_bfe_u32 v45, v43, 2, 1
    v_or_b32 v44, v45, v44
    v_xor_b32 v44, v44, v41
    v_lshlrev_b32 v44, 4, v44
    v_lshl_add_u32 v44, v40, 7, v44
    v_add_u32 v44, 4096, v44
    v_add_u32 v5, s49, v44
    v_add_u32 v42, 40, v40
    v_mul_u32_u24 v43, 0x5556, v42
    v_lshrrev_b32 v43, 16, v43
    v_bfe_u32 v44, v43, 1, 1
    v_lshlrev_b32 v44, 2, v44
    v_bfe_u32 v45, v43, 3, 1
    v_lshl_or_b32 v44, v45, 1, v44
    v_bfe_u32 v45, v43, 2, 1
    v_or_b32 v44, v45, v44
    v_xor_b32 v44, v44, v41
    v_lshlrev_b32 v44, 4, v44
    v_lshl_add_u32 v44, v40, 7, v44
    v_add_u32 v44, 4096, v44
    v_add_u32 v6, s49, v44
    v_lshrrev_b32 v46, 5, v0
    v_and_b32 v47, 31, v0
    v_bfe_u32 v48, v0, 4, 1
    v_bfe_u32 v49, v0, 2, 2
    v_and_b32 v50, 3, v0
    v_lshrrev_b32 v51, 1, v50
    v_lshl_or_b32 v51, v48, 1, v51
    v_and_b32 v52, 1, v50
    v_lshlrev_b32 v52, 3, v52
    v_lshl_add_u32 v42, v46, 3, v49
    v_bfe_u32 v44, v42, 1, 1
    v_lshlrev_b32 v44, 2, v44
    v_bfe_u32 v45, v42, 3, 1
    v_lshl_or_b32 v44, v45, 1, v44
    v_bfe_u32 v45, v42, 2, 1
    v_or_b32 v44, v45, v44
    v_xor_b32 v44, v44, v51
    v_lshlrev_b32 v44, 4, v44
    v_add_u32 v44, v44, v52
    v_mul_u32_u24 v42, 0x180, v42
    v_add_u32 v12, v42, v44
    v_xor_b32 v14, 64, v12
    v_lshl_add_u32 v42, v46, 3, v49
    v_add_u32 v42, 4, v42
    v_bfe_u32 v44, v42, 1, 1
    v_lshlrev_b32 v44, 2, v44
    v_bfe_u32 v45, v42, 3, 1
    v_lshl_or_b32 v44, v45, 1, v44
    v_bfe_u32 v45, v42, 2, 1
    v_or_b32 v44, v45, v44
    v_xor_b32 v44, v44, v51
    v_lshlrev_b32 v44, 4, v44
    v_add_u32 v44, v44, v52
    v_mul_u32_u24 v42, 0x180, v42
    v_add_u32 v13, v42, v44
    v_xor_b32 v15, 64, v13
    v_lshl_add_u32 v42, v46, 2, v49
    v_bfe_u32 v44, v42, 1, 1
    v_lshlrev_b32 v44, 2, v44
    v_bfe_u32 v45, v42, 3, 1
    v_lshl_or_b32 v44, v45, 1, v44
    v_bfe_u32 v45, v42, 2, 1
    v_or_b32 v44, v45, v44
    v_xor_b32 v44, v44, v51
    v_lshlrev_b32 v44, 4, v44
    v_add_u32 v44, v44, v52
    v_mul_u32_u24 v42, 0x180, v42
    v_add_u32 v22, v42, v44
    v_xor_b32 v24, 64, v22
    v_lshl_add_u32 v42, v46, 2, v49
    v_add_u32 v42, 8, v42
    v_bfe_u32 v44, v42, 1, 1
    v_lshlrev_b32 v44, 2, v44
    v_bfe_u32 v45, v42, 3, 1
    v_lshl_or_b32 v44, v45, 1, v44
    v_bfe_u32 v45, v42, 2, 1
    v_or_b32 v44, v45, v44
    v_xor_b32 v44, v44, v51
    v_lshlrev_b32 v44, 4, v44
    v_add_u32 v44, v44, v52
    v_mul_u32_u24 v42, 0x180, v42
    v_add_u32 v23, v42, v44
    v_xor_b32 v25, 64, v23
    v_bfe_u32 v42, v47, 1, 3
    v_xor_b32 v42, v42, v46
    v_lshlrev_b32 v42, 4, v42
    v_lshl_add_u32 v42, v47, 7, v42
    v_add_u32 v26, s51, v42
    v_xor_b32 v27, 32, v26
    v_xor_b32 v28, 64, v26
    v_xor_b32 v29, 96, v26
    v_bfe_u32 v44, v47, 1, 1
    v_lshlrev_b32 v44, 2, v44
    v_bfe_u32 v45, v47, 3, 1
    v_lshl_or_b32 v44, v45, 1, v44
    v_bfe_u32 v45, v47, 2, 1
    v_or_b32 v44, v45, v44
    v_xor_b32 v44, v44, v46
    v_lshlrev_b32 v44, 4, v44
    v_mul_u32_u24 v42, 0x180, v47
    v_add_u32 v18, v42, v44
    v_xor_b32 v19, 32, v18
    v_xor_b32 v20, 64, v18
    v_xor_b32 v21, 96, v18
    v_mov_b32 v160, 0
    v_mov_b32 v161, 0
    v_mov_b32 v162, 0
    v_mov_b32 v163, 0
    v_mov_b32 v164, 0
    v_mov_b32 v165, 0
    v_mov_b32 v166, 0
    v_mov_b32 v167, 0
    v_mov_b32 v168, 0
    v_mov_b32 v169, 0
    v_mov_b32 v170, 0
    v_mov_b32 v171, 0
    v_mov_b32 v172, 0
    v_mov_b32 v173, 0
    v_mov_b32 v174, 0
    v_mov_b32 v175, 0
    v_mov_b32 v176, 0
    v_mov_b32 v177, 0
    v_mov_b32 v178, 0
    v_mov_b32 v179, 0
    v_mov_b32 v180, 0
    v_mov_b32 v181, 0
    v_mov_b32 v182, 0
    v_mov_b32 v183, 0
    v_mov_b32 v184, 0
    v_mov_b32 v185, 0
    v_mov_b32 v186, 0
    v_mov_b32 v187, 0
    v_mov_b32 v188, 0
    v_mov_b32 v189, 0
    v_mov_b32 v190, 0
    v_mov_b32 v191, 0
    v_mov_b32 v192, 0
    v_mov_b32 v193, 0
    v_mov_b32 v194, 0
    v_mov_b32 v195, 0
    v_mov_b32 v196, 0
    v_mov_b32 v197, 0
    v_mov_b32 v198, 0
    v_mov_b32 v199, 0
    v_mov_b32 v200, 0
    v_mov_b32 v201, 0
    v_mov_b32 v202, 0
    v_mov_b32 v203, 0
    v_mov_b32 v204, 0
    v_mov_b32 v205, 0
    v_mov_b32 v206, 0
    v_mov_b32 v207, 0
    v_mov_b32 v208, 0
    v_mov_b32 v209, 0
    v_mov_b32 v210, 0
    v_mov_b32 v211, 0
    v_mov_b32 v212, 0
    v_mov_b32 v213, 0
    v_mov_b32 v214, 0
    v_mov_b32 v215, 0
    v_mov_b32 v216, 0
    v_mov_b32 v217, 0
    v_mov_b32 v218, 0
    v_mov_b32 v219, 0
    v_mov_b32 v220, 0
    v_mov_b32 v221, 0
    v_mov_b32 v222, 0
    v_mov_b32 v223, 0
    v_mov_b32 v224, 0
    v_mov_b32 v225, 0
    v_mov_b32 v226, 0
    v_mov_b32 v227, 0
    v_mov_b32 v228, 0
    v_mov_b32 v229, 0
    v_mov_b32 v230, 0
    v_mov_b32 v231, 0
    v_mov_b32 v232, 0
    v_mov_b32 v233, 0
    v_mov_b32 v234, 0
    v_mov_b32 v235, 0
    v_mov_b32 v236, 0
    v_mov_b32 v237, 0
    v_mov_b32 v238, 0
    v_mov_b32 v239, 0
    v_mov_b32 v240, 0
    v_mov_b32 v241, 0
    v_mov_b32 v242, 0
    v_mov_b32 v243, 0
    v_mov_b32 v244, 0
    v_mov_b32 v245, 0
    v_mov_b32 v246, 0
    v_mov_b32 v247, 0
    v_mov_b32 v248, 0
    v_mov_b32 v249, 0
    v_mov_b32 v250, 0
    v_mov_b32 v251, 0
    v_mov_b32 v252, 0
    v_mov_b32 v253, 0
    v_mov_b32 v254, 0
    v_mov_b32 v255, 0
    s_mov_b32 s61, 0
    s_waitcnt vmcnt(3)
    s_barrier
    ds_read_b128 v[64:67], v26 offset:0
    ds_read_b128 v[68:71], v27 offset:0
    ds_read_b128 v[72:75], v28 offset:0
    ds_read_b128 v[76:79], v29 offset:0
    ds_read_b64_tr_b16 v[32:33], v12 offset:0
    ds_read_b64_tr_b16 v[34:35], v13 offset:0
    s_add_u32 m0, s51, 16384
    s_add_u32 s65, s54, 18432
    buffer_load_dwordx4 v10, s[28:31], s54 offen lds
    ds_read_b64_tr_b16 v[36:37], v14 offset:0
    ds_read_b64_tr_b16 v[38:39], v15 offset:0
    buffer_load_dwordx4 v11, s[28:31], s54 offen offset:1024 lds
    ds_read_b64_tr_b16 v[40:41], v12 offset:128
    ds_read_b64_tr_b16 v[42:43], v13 offset:128
    buffer_load_dwordx4 v10, s[28:31], s65 offen offset:2048 lds
    ds_read_b64_tr_b16 v[44:45], v14 offset:128
    ds_read_b64_tr_b16 v[46:47], v15 offset:128
    buffer_load_dwordx4 v11, s[28:31], s65 offen offset:3072 lds
    s_add_u32 s54, s54, 128
    ds_read_b64_tr_b16 v[48:49], v12 offset:256
    ds_read_b64_tr_b16 v[50:51], v13 offset:256
    ds_read_b64_tr_b16 v[52:53], v14 offset:256
    ds_read_b64_tr_b16 v[54:55], v15 offset:256
    ds_read_b64_tr_b16 v[56:57], v12 offset:6144
    ds_read_b64_tr_b16 v[58:59], v13 offset:6144
    s_add_u32 m0, s50, 24576
    s_nop 0
    buffer_load_dwordx4 v7, s[32:35], s53 offen lds
    buffer_load_dwordx4 v8, s[32:35], s53 offen offset:1024 lds
    buffer_load_dwordx4 v9, s[32:35], s53 offen offset:2048 lds
    s_add_u32 s53, s53, 393216
attn_qloop:
    s_waitcnt lgkmcnt(12)
    v_mfma_f32_32x32x16_bf16 v[160:175], v[32:35], v[64:67], v[160:175]
    ds_read_b64_tr_b16 v[60:61], v14 offset:6144
    ds_read_b64_tr_b16 v[62:63], v15 offset:6144
    s_waitcnt lgkmcnt(12)
    v_mfma_f32_32x32x16_bf16 v[176:191], v[36:39], v[64:67], v[176:191]
    ds_read_b64_tr_b16 v[32:33], v12 offset:6272
    ds_read_b64_tr_b16 v[34:35], v13 offset:6272
    s_waitcnt lgkmcnt(12)
    v_mfma_f32_32x32x16_bf16 v[192:207], v[40:43], v[64:67], v[192:207]
    ds_read_b64_tr_b16 v[36:37], v14 offset:6272
    ds_read_b64_tr_b16 v[38:39], v15 offset:6272
    s_waitcnt lgkmcnt(12)
    v_mfma_f32_32x32x16_bf16 v[208:223], v[44:47], v[64:67], v[208:223]
    ds_read_b64_tr_b16 v[40:41], v12 offset:6400
    ds_read_b64_tr_b16 v[42:43], v13 offset:6400
    s_waitcnt lgkmcnt(12)
    v_mfma_f32_32x32x16_bf16 v[224:239], v[48:51], v[64:67], v[224:239]
    ds_read_b64_tr_b16 v[44:45], v14 offset:6400
    ds_read_b64_tr_b16 v[46:47], v15 offset:6400
    s_waitcnt lgkmcnt(12)
    v_mfma_f32_32x32x16_bf16 v[240:255], v[52:55], v[64:67], v[240:255]
    s_waitcnt vmcnt(7)
    s_barrier
    ds_read_b64_tr_b16 v[48:49], v12 offset:12288
    ds_read_b64_tr_b16 v[50:51], v13 offset:12288
    s_add_u32 m0, s50, 36864
    s_nop 0
    buffer_load_dwordx4 v7, s[32:35], s53 offen lds
    s_waitcnt lgkmcnt(12)
    v_mfma_f32_32x32x16_bf16 v[160:175], v[56:59], v[68:71], v[160:175]
    ds_read_b64_tr_b16 v[52:53], v14 offset:12288
    ds_read_b64_tr_b16 v[54:55], v15 offset:12288
    buffer_load_dwordx4 v8, s[32:35], s53 offen offset:1024 lds
    s_waitcnt lgkmcnt(12)
    v_mfma_f32_32x32x16_bf16 v[176:191], v[60:63], v[68:71], v[176:191]
    ds_read_b64_tr_b16 v[56:57], v12 offset:12416
    ds_read_b64_tr_b16 v[58:59], v13 offset:12416
    buffer_load_dwordx4 v9, s[32:35], s53 offen offset:2048 lds
    s_add_u32 s53, s53, 393216
    s_waitcnt lgkmcnt(12)
    v_mfma_f32_32x32x16_bf16 v[192:207], v[32:35], v[68:71], v[192:207]
    ds_read_b64_tr_b16 v[60:61], v14 offset:12416
    ds_read_b64_tr_b16 v[62:63], v15 offset:12416
    s_waitcnt lgkmcnt(12)
    v_mfma_f32_32x32x16_bf16 v[208:223], v[36:39], v[68:71], v[208:223]
    ds_read_b64_tr_b16 v[32:33], v12 offset:12544
    ds_read_b64_tr_b16 v[34:35], v13 offset:12544
    s_waitcnt lgkmcnt(12)
    v_mfma_f32_32x32x16_bf16 v[224:239], v[40:43], v[68:71], v[224:239]
    ds_read_b64_tr_b16 v[36:37], v14 offset:12544
    ds_read_b64_tr_b16 v[38:39], v15 offset:12544
    s_waitcnt lgkmcnt(12)
    v_mfma_f32_32x32x16_bf16 v[240:255], v[44:47], v[68:71], v[240:255]
    ds_read_b64_tr_b16 v[40:41], v12 offset:18432
    ds_read_b64_tr_b16 v[42:43], v13 offset:18432
    s_waitcnt lgkmcnt(12)
    v_mfma_f32_32x32x16_bf16 v[160:175], v[48:51], v[72:75], v[160:175]
    ds_read_b64_tr_b16 v[44:45], v14 offset:18432
    ds_read_b64_tr_b16 v[46:47], v15 offset:18432
    s_waitcnt lgkmcnt(12)
    v_mfma_f32_32x32x16_bf16 v[176:191], v[52:55], v[72:75], v[176:191]
    ds_read_b64_tr_b16 v[48:49], v12 offset:18560
    ds_read_b64_tr_b16 v[50:51], v13 offset:18560
    s_waitcnt lgkmcnt(12)
    v_mfma_f32_32x32x16_bf16 v[192:207], v[56:59], v[72:75], v[192:207]
    ds_read_b64_tr_b16 v[52:53], v14 offset:18560
    ds_read_b64_tr_b16 v[54:55], v15 offset:18560
    s_waitcnt lgkmcnt(12)
    v_mfma_f32_32x32x16_bf16 v[208:223], v[60:63], v[72:75], v[208:223]
    ds_read_b64_tr_b16 v[56:57], v12 offset:18688
    ds_read_b64_tr_b16 v[58:59], v13 offset:18688
    s_waitcnt lgkmcnt(12)
    v_mfma_f32_32x32x16_bf16 v[224:239], v[32:35], v[72:75], v[224:239]
    ds_read_b64_tr_b16 v[60:61], v14 offset:18688
    ds_read_b64_tr_b16 v[62:63], v15 offset:18688
    s_waitcnt lgkmcnt(12)
    v_mfma_f32_32x32x16_bf16 v[240:255], v[36:39], v[72:75], v[240:255]
    s_waitcnt vmcnt(3)
    s_barrier
    ds_read_b128 v[80:83], v26 offset:16384
    ds_read_b128 v[84:87], v27 offset:16384
    ds_read_b128 v[88:91], v28 offset:16384
    ds_read_b128 v[92:95], v29 offset:16384
    ds_read_b64_tr_b16 v[32:33], v12 offset:24576
    ds_read_b64_tr_b16 v[34:35], v13 offset:24576
    s_add_u32 m0, s51, 0
    s_add_u32 s65, s54, 18432
    buffer_load_dwordx4 v10, s[28:31], s54 offen lds
    s_waitcnt lgkmcnt(15)
    v_mfma_f32_32x32x16_bf16 v[160:175], v[40:43], v[76:79], v[160:175]
    ds_read_b64_tr_b16 v[36:37], v14 offset:24576
    ds_read_b64_tr_b16 v[38:39], v15 offset:24576
    buffer_load_dwordx4 v11, s[28:31], s54 offen offset:1024 lds
    s_waitcnt lgkmcnt(15)
    v_mfma_f32_32x32x16_bf16 v[176:191], v[44:47], v[76:79], v[176:191]
    ds_read_b64_tr_b16 v[40:41], v12 offset:24704
    ds_read_b64_tr_b16 v[42:43], v13 offset:24704
    buffer_load_dwordx4 v10, s[28:31], s65 offen offset:2048 lds
    s_waitcnt lgkmcnt(15)
    v_mfma_f32_32x32x16_bf16 v[192:207], v[48:51], v[76:79], v[192:207]
    ds_read_b64_tr_b16 v[44:45], v14 offset:24704
    ds_read_b64_tr_b16 v[46:47], v15 offset:24704
    buffer_load_dwordx4 v11, s[28:31], s65 offen offset:3072 lds
    s_add_u32 s54, s54, 128
    s_waitcnt lgkmcnt(15)
    v_mfma_f32_32x32x16_bf16 v[208:223], v[52:55], v[76:79], v[208:223]
    ds_read_b64_tr_b16 v[48:49], v12 offset:24832
    ds_read_b64_tr_b16 v[50:51], v13 offset:24832
    s_add_u32 m0, s50, 0
    s_nop 0
    buffer_load_dwordx4 v7, s[32:35], s53 offen lds
    s_waitcnt lgkmcnt(15)
    v_mfma_f32_32x32x16_bf16 v[224:239], v[56:59], v[76:79], v[224:239]
    ds_read_b64_tr_b16 v[52:53], v14 offset:24832
    ds_read_b64_tr_b16 v[54:55], v15 offset:24832
    buffer_load_dwordx4 v8, s[32:35], s53 offen offset:1024 lds
    s_waitcnt lgkmcnt(15)
    v_mfma_f32_32x32x16_bf16 v[240:255], v[60:63], v[76:79], v[240:255]
    ds_read_b64_tr_b16 v[56:57], v12 offset:30720
    ds_read_b64_tr_b16 v[58:59], v13 offset:30720
    buffer_load_dwordx4 v9, s[32:35], s53 offen offset:2048 lds
    s_add_u32 s53, s53, 393216
    s_waitcnt lgkmcnt(12)
    v_mfma_f32_32x32x16_bf16 v[160:175], v[32:35], v[80:83], v[160:175]
    ds_read_b64_tr_b16 v[60:61], v14 offset:30720
    ds_read_b64_tr_b16 v[62:63], v15 offset:30720
    s_waitcnt lgkmcnt(12)
    v_mfma_f32_32x32x16_bf16 v[176:191], v[36:39], v[80:83], v[176:191]
    ds_read_b64_tr_b16 v[32:33], v12 offset:30848
    ds_read_b64_tr_b16 v[34:35], v13 offset:30848
    s_waitcnt lgkmcnt(12)
    v_mfma_f32_32x32x16_bf16 v[192:207], v[40:43], v[80:83], v[192:207]
    ds_read_b64_tr_b16 v[36:37], v14 offset:30848
    ds_read_b64_tr_b16 v[38:39], v15 offset:30848
    s_waitcnt lgkmcnt(12)
    v_mfma_f32_32x32x16_bf16 v[208:223], v[44:47], v[80:83], v[208:223]
    ds_read_b64_tr_b16 v[40:41], v12 offset:30976
    ds_read_b64_tr_b16 v[42:43], v13 offset:30976
    s_waitcnt lgkmcnt(12)
    v_mfma_f32_32x32x16_bf16 v[224:239], v[48:51], v[80:83], v[224:239]
    ds_read_b64_tr_b16 v[44:45], v14 offset:30976
    ds_read_b64_tr_b16 v[46:47], v15 offset:30976
    s_waitcnt lgkmcnt(12)
    v_mfma_f32_32x32x16_bf16 v[240:255], v[52:55], v[80:83], v[240:255]
    s_waitcnt vmcnt(7)
    s_barrier
    ds_read_b64_tr_b16 v[48:49], v12 offset:36864
    ds_read_b64_tr_b16 v[50:51], v13 offset:36864
    s_add_u32 m0, s50, 12288
    s_nop 0
    buffer_load_dwordx4 v7, s[32:35], s53 offen lds
    s_waitcnt lgkmcnt(12)
    v_mfma_f32_32x32x16_bf16 v[160:175], v[56:59], v[84:87], v[160:175]
    ds_read_b64_tr_b16 v[52:53], v14 offset:36864
    ds_read_b64_tr_b16 v[54:55], v15 offset:36864
    buffer_load_dwordx4 v8, s[32:35], s53 offen offset:1024 lds
    s_waitcnt lgkmcnt(12)
    v_mfma_f32_32x32x16_bf16 v[176:191], v[60:63], v[84:87], v[176:191]
    ds_read_b64_tr_b16 v[56:57], v12 offset:36992
    ds_read_b64_tr_b16 v[58:59], v13 offset:36992
    buffer_load_dwordx4 v9, s[32:35], s53 offen offset:2048 lds
    s_add_u32 s53, s53, 393216
    s_waitcnt lgkmcnt(12)
    v_mfma_f32_32x32x16_bf16 v[192:207], v[32:35], v[84:87], v[192:207]
    ds_read_b64_tr_b16 v[60:61], v14 offset:36992
    ds_read_b64_tr_b16 v[62:63], v15 offset:36992
    s_waitcnt lgkmcnt(12)
    v_mfma_f32_32x32x16_bf16 v[208:223], v[36:39], v[84:87], v[208:223]
    ds_read_b64_tr_b16 v[32:33], v12 offset:37120
    ds_read_b64_tr_b16 v[34:35], v13 offset:37120
    s_waitcnt lgkmcnt(12)
    v_mfma_f32_32x32x16_bf16 v[224:239], v[40:43], v[84:87], v[224:239]
    ds_read_b64_tr_b16 v[36:37], v14 offset:37120
    ds_read_b64_tr_b16 v[38:39], v15 offset:37120
    s_waitcnt lgkmcnt(12)
    v_mfma_f32_32x32x16_bf16 v[240:255], v[44:47], v[84:87], v[240:255]
    ds_read_b64_tr_b16 v[40:41], v12 offset:43008
    ds_read_b64_tr_b16 v[42:43], v13 offset:43008
    s_waitcnt lgkmcnt(12)
    v_mfma_f32_32x32x16_bf16 v[160:175], v[48:51], v[88:91], v[160:175]
    ds_read_b64_tr_b16 v[44:45], v14 offset:43008
    ds_read_b64_tr_b16 v[46:47], v15 offset:43008
    s_waitcnt lgkmcnt(12)
    v_mfma_f32_32x32x16_bf16 v[176:191], v[52:55], v[88:91], v[176:191]
    ds_read_b64_tr_b16 v[48:49], v12 offset:43136
    ds_read_b64_tr_b16 v[50:51], v13 offset:43136
    s_waitcnt lgkmcnt(12)
    v_mfma_f32_32x32x16_bf16 v[192:207], v[56:59], v[88:91], v[192:207]
    ds_read_b64_tr_b16 v[52:53], v14 offset:43136
    ds_read_b64_tr_b16 v[54:55], v15 offset:43136
    s_waitcnt lgkmcnt(12)
    v_mfma_f32_32x32x16_bf16 v[208:223], v[60:63], v[88:91], v[208:223]
    ds_read_b64_tr_b16 v[56:57], v12 offset:43264
    ds_read_b64_tr_b16 v[58:59], v13 offset:43264
    s_waitcnt lgkmcnt(12)
    v_mfma_f32_32x32x16_bf16 v[224:239], v[32:35], v[88:91], v[224:239]
    ds_read_b64_tr_b16 v[60:61], v14 offset:43264
    ds_read_b64_tr_b16 v[62:63], v15 offset:43264
    s_waitcnt lgkmcnt(12)
    v_mfma_f32_32x32x16_bf16 v[240:255], v[36:39], v[88:91], v[240:255]
    s_waitcnt vmcnt(3)
    s_barrier
    ds_read_b128 v[64:67], v26 offset:0
    ds_read_b128 v[68:71], v27 offset:0
    ds_read_b128 v[72:75], v28 offset:0
    ds_read_b128 v[76:79], v29 offset:0
    ds_read_b64_tr_b16 v[32:33], v12 offset:0
    ds_read_b64_tr_b16 v[34:35], v13 offset:0
    s_add_u32 m0, s51, 16384
    s_add_u32 s65, s54, 18432
    buffer_load_dwordx4 v10, s[28:31], s54 offen lds
    s_waitcnt lgkmcnt(15)
    v_mfma_f32_32x32x16_bf16 v[160:175], v[40:43], v[92:95], v[160:175]
    ds_read_b64_tr_b16 v[36:37], v14 offset:0
    ds_read_b64_tr_b16 v[38:39], v15 offset:0
    buffer_load_dwordx4 v11, s[28:31], s54 offen offset:1024 lds
    s_waitcnt lgkmcnt(15)
    v_mfma_f32_32x32x16_bf16 v[176:191], v[44:47], v[92:95], v[176:191]
    ds_read_b64_tr_b16 v[40:41], v12 offset:128
    ds_read_b64_tr_b16 v[42:43], v13 offset:128
    buffer_load_dwordx4 v10, s[28:31], s65 offen offset:2048 lds
    s_waitcnt lgkmcnt(15)
    v_mfma_f32_32x32x16_bf16 v[192:207], v[48:51], v[92:95], v[192:207]
    ds_read_b64_tr_b16 v[44:45], v14 offset:128
    ds_read_b64_tr_b16 v[46:47], v15 offset:128
    buffer_load_dwordx4 v11, s[28:31], s65 offen offset:3072 lds
    s_add_u32 s54, s54, 128
    s_waitcnt lgkmcnt(15)
    v_mfma_f32_32x32x16_bf16 v[208:223], v[52:55], v[92:95], v[208:223]
    ds_read_b64_tr_b16 v[48:49], v12 offset:256
    ds_read_b64_tr_b16 v[50:51], v13 offset:256
    s_add_u32 m0, s50, 24576
    s_nop 0
    buffer_load_dwordx4 v7, s[32:35], s53 offen lds
    s_waitcnt lgkmcnt(15)
    v_mfma_f32_32x32x16_bf16 v[224:239], v[56:59], v[92:95], v[224:239]
    ds_read_b64_tr_b16 v[52:53], v14 offset:256
    ds_read_b64_tr_b16 v[54:55], v15 offset:256
    buffer_load_dwordx4 v8, s[32:35], s53 offen offset:1024 lds
    s_waitcnt lgkmcnt(15)
    v_mfma_f32_32x32x16_bf16 v[240:255], v[60:63], v[92:95], v[240:255]
    ds_read_b64_tr_b16 v[56:57], v12 offset:6144
    ds_read_b64_tr_b16 v[58:59], v13 offset:6144
    buffer_load_dwordx4 v9, s[32:35], s53 offen offset:2048 lds
    s_add_u32 s53, s53, 393216
    s_add_u32 s61, s61, 1
    s_cmp_lt_u32 s61, 4
    s_cbranch_scc1 attn_qloop
    s_waitcnt lgkmcnt(12)
    v_mfma_f32_32x32x16_bf16 v[160:175], v[32:35], v[64:67], v[160:175]
    ds_read_b64_tr_b16 v[60:61], v14 offset:6144
    ds_read_b64_tr_b16 v[62:63], v15 offset:6144
    s_waitcnt lgkmcnt(12)
    v_mfma_f32_32x32x16_bf16 v[176:191], v[36:39], v[64:67], v[176:191]
    ds_read_b64_tr_b16 v[32:33], v12 offset:6272
    ds_read_b64_tr_b16 v[34:35], v13 offset:6272
    s_waitcnt lgkmcnt(12)
    v_mfma_f32_32x32x16_bf16 v[192:207], v[40:43], v[64:67], v[192:207]
    ds_read_b64_tr_b16 v[36:37], v14 offset:6272
    ds_read_b64_tr_b16 v[38:39], v15 offset:6272
    s_waitcnt lgkmcnt(12)
    v_mfma_f32_32x32x16_bf16 v[208:223], v[44:47], v[64:67], v[208:223]
    ds_read_b64_tr_b16 v[40:41], v12 offset:6400
    ds_read_b64_tr_b16 v[42:43], v13 offset:6400
    s_waitcnt lgkmcnt(12)
    v_mfma_f32_32x32x16_bf16 v[224:239], v[48:51], v[64:67], v[224:239]
    ds_read_b64_tr_b16 v[44:45], v14 offset:6400
    ds_read_b64_tr_b16 v[46:47], v15 offset:6400
    s_waitcnt lgkmcnt(12)
    v_mfma_f32_32x32x16_bf16 v[240:255], v[52:55], v[64:67], v[240:255]
    s_waitcnt vmcnt(7)
    s_barrier
    ds_read_b64_tr_b16 v[48:49], v12 offset:12288
    ds_read_b64_tr_b16 v[50:51], v13 offset:12288
    s_add_u32 m0, s50, 36864
    s_nop 0
    buffer_load_dwordx4 v7, s[32:35], s53 offen lds
    s_waitcnt lgkmcnt(12)
    v_mfma_f32_32x32x16_bf16 v[160:175], v[56:59], v[68:71], v[160:175]
    ds_read_b64_tr_b16 v[52:53], v14 offset:12288
    ds_read_b64_tr_b16 v[54:55], v15 offset:12288
    buffer_load_dwordx4 v8, s[32:35], s53 offen offset:1024 lds
    s_waitcnt lgkmcnt(12)
    v_mfma_f32_32x32x16_bf16 v[176:191], v[60:63], v[68:71], v[176:191]
    ds_read_b64_tr_b16 v[56:57], v12 offset:12416
    ds_read_b64_tr_b16 v[58:59], v13 offset:12416
    buffer_load_dwordx4 v9, s[32:35], s53 offen offset:2048 lds
    s_add_u32 s53, s53, 393216
    s_waitcnt lgkmcnt(12)
    v_mfma_f32_32x32x16_bf16 v[192:207], v[32:35], v[68:71], v[192:207]
    ds_read_b64_tr_b16 v[60:61], v14 offset:12416
    ds_read_b64_tr_b16 v[62:63], v15 offset:12416
    s_waitcnt lgkmcnt(12)
    v_mfma_f32_32x32x16_bf16 v[208:223], v[36:39], v[68:71], v[208:223]
    ds_read_b64_tr_b16 v[32:33], v12 offset:12544
    ds_read_b64_tr_b16 v[34:35], v13 offset:12544
    s_waitcnt lgkmcnt(12)
    v_mfma_f32_32x32x16_bf16 v[224:239], v[40:43], v[68:71], v[224:239]
    ds_read_b64_tr_b16 v[36:37], v14 offset:12544
    ds_read_b64_tr_b16 v[38:39], v15 offset:12544
    s_waitcnt lgkmcnt(12)
    v_mfma_f32_32x32x16_bf16 v[240:255], v[44:47], v[68:71], v[240:255]
    ds_read_b64_tr_b16 v[40:41], v12 offset:18432
    ds_read_b64_tr_b16 v[42:43], v13 offset:18432
    s_waitcnt lgkmcnt(12)
    v_mfma_f32_32x32x16_bf16 v[160:175], v[48:51], v[72:75], v[160:175]
    ds_read_b64_tr_b16 v[44:45], v14 offset:18432
    ds_read_b64_tr_b16 v[46:47], v15 offset:18432
    s_waitcnt lgkmcnt(12)
    v_mfma_f32_32x32x16_bf16 v[176:191], v[52:55], v[72:75], v[176:191]
    ds_read_b64_tr_b16 v[48:49], v12 offset:18560
    ds_read_b64_tr_b16 v[50:51], v13 offset:18560
    s_waitcnt lgkmcnt(12)
    v_mfma_f32_32x32x16_bf16 v[192:207], v[56:59], v[72:75], v[192:207]
    ds_read_b64_tr_b16 v[52:53], v14 offset:18560
    ds_read_b64_tr_b16 v[54:55], v15 offset:18560
    s_waitcnt lgkmcnt(12)
    v_mfma_f32_32x32x16_bf16 v[208:223], v[60:63], v[72:75], v[208:223]
    ds_read_b64_tr_b16 v[56:57], v12 offset:18688
    ds_read_b64_tr_b16 v[58:59], v13 offset:18688
    s_waitcnt lgkmcnt(12)
    v_mfma_f32_32x32x16_bf16 v[224:239], v[32:35], v[72:75], v[224:239]
    ds_read_b64_tr_b16 v[60:61], v14 offset:18688
    ds_read_b64_tr_b16 v[62:63], v15 offset:18688
    s_waitcnt lgkmcnt(12)
    v_mfma_f32_32x32x16_bf16 v[240:255], v[36:39], v[72:75], v[240:255]
    s_waitcnt vmcnt(3)
    s_barrier
    ds_read_b128 v[80:83], v26 offset:16384
    ds_read_b128 v[84:87], v27 offset:16384
    ds_read_b128 v[88:91], v28 offset:16384
    ds_read_b128 v[92:95], v29 offset:16384
    ds_read_b64_tr_b16 v[32:33], v12 offset:24576
    ds_read_b64_tr_b16 v[34:35], v13 offset:24576
    s_waitcnt lgkmcnt(15)
    v_mfma_f32_32x32x16_bf16 v[160:175], v[40:43], v[76:79], v[160:175]
    ds_read_b64_tr_b16 v[36:37], v14 offset:24576
    ds_read_b64_tr_b16 v[38:39], v15 offset:24576
    s_waitcnt lgkmcnt(15)
    v_mfma_f32_32x32x16_bf16 v[176:191], v[44:47], v[76:79], v[176:191]
    ds_read_b64_tr_b16 v[40:41], v12 offset:24704
    ds_read_b64_tr_b16 v[42:43], v13 offset:24704
    s_waitcnt lgkmcnt(15)
    v_mfma_f32_32x32x16_bf16 v[192:207], v[48:51], v[76:79], v[192:207]
    ds_read_b64_tr_b16 v[44:45], v14 offset:24704
    ds_read_b64_tr_b16 v[46:47], v15 offset:24704
    s_waitcnt lgkmcnt(15)
    v_mfma_f32_32x32x16_bf16 v[208:223], v[52:55], v[76:79], v[208:223]
    ds_read_b64_tr_b16 v[48:49], v12 offset:24832
    ds_read_b64_tr_b16 v[50:51], v13 offset:24832
    s_waitcnt lgkmcnt(15)
    v_mfma_f32_32x32x16_bf16 v[224:239], v[56:59], v[76:79], v[224:239]
    ds_read_b64_tr_b16 v[52:53], v14 offset:24832
    ds_read_b64_tr_b16 v[54:55], v15 offset:24832
    s_waitcnt lgkmcnt(15)
    v_mfma_f32_32x32x16_bf16 v[240:255], v[60:63], v[76:79], v[240:255]
    ds_read_b64_tr_b16 v[56:57], v12 offset:30720
    ds_read_b64_tr_b16 v[58:59], v13 offset:30720
    s_waitcnt lgkmcnt(12)
    v_mfma_f32_32x32x16_bf16 v[160:175], v[32:35], v[80:83], v[160:175]
    ds_read_b64_tr_b16 v[60:61], v14 offset:30720
    ds_read_b64_tr_b16 v[62:63], v15 offset:30720
    s_waitcnt lgkmcnt(12)
    v_mfma_f32_32x32x16_bf16 v[176:191], v[36:39], v[80:83], v[176:191]
    ds_read_b64_tr_b16 v[32:33], v12 offset:30848
    ds_read_b64_tr_b16 v[34:35], v13 offset:30848
    s_waitcnt lgkmcnt(12)
    v_mfma_f32_32x32x16_bf16 v[192:207], v[40:43], v[80:83], v[192:207]
    ds_read_b64_tr_b16 v[36:37], v14 offset:30848
    ds_read_b64_tr_b16 v[38:39], v15 offset:30848
    s_waitcnt lgkmcnt(12)
    v_mfma_f32_32x32x16_bf16 v[208:223], v[44:47], v[80:83], v[208:223]
    ds_read_b64_tr_b16 v[40:41], v12 offset:30976
    ds_read_b64_tr_b16 v[42:43], v13 offset:30976
    s_waitcnt lgkmcnt(12)
    v_mfma_f32_32x32x16_bf16 v[224:239], v[48:51], v[80:83], v[224:239]
    ds_read_b64_tr_b16 v[44:45], v14 offset:30976
    ds_read_b64_tr_b16 v[46:47], v15 offset:30976
    s_waitcnt lgkmcnt(12)
    v_mfma_f32_32x32x16_bf16 v[240:255], v[52:55], v[80:83], v[240:255]
    s_waitcnt vmcnt(0)
    s_barrier
    s_mov_b32 s55, 0
    s_add_u32 s62, s49, 49152
    ds_read_b64_tr_b16 v[48:49], v12 offset:36864
    ds_read_b64_tr_b16 v[50:51], v13 offset:36864
    s_mov_b32 m0, s49
    s_nop 0
    buffer_load_dwordx4 v1, s[36:39], s55 offen offset:0 nt lds
    s_waitcnt lgkmcnt(12)
    v_mfma_f32_32x32x16_bf16 v[160:175], v[56:59], v[84:87], v[160:175]
    ds_read_b64_tr_b16 v[52:53], v14 offset:36864
    ds_read_b64_tr_b16 v[54:55], v15 offset:36864
    buffer_load_dwordx4 v2, s[36:39], s55 offen offset:1024 nt lds
    s_waitcnt lgkmcnt(12)
    v_mfma_f32_32x32x16_bf16 v[176:191], v[60:63], v[84:87], v[176:191]
    ds_read_b64_tr_b16 v[56:57], v12 offset:36992
    ds_read_b64_tr_b16 v[58:59], v13 offset:36992
    buffer_load_dwordx4 v3, s[36:39], s55 offen offset:2048 nt lds
    s_waitcnt lgkmcnt(12)
    v_mfma_f32_32x32x16_bf16 v[192:207], v[32:35], v[84:87], v[192:207]
    ds_read_b64_tr_b16 v[60:61], v14 offset:36992
    ds_read_b64_tr_b16 v[62:63], v15 offset:36992
    buffer_load_dwordx4 v4, s[36:39], s55 offen offset:3072 nt lds
    s_waitcnt lgkmcnt(12)
    v_mfma_f32_32x32x16_bf16 v[208:223], v[36:39], v[84:87], v[208:223]
    ds_read_b64_tr_b16 v[32:33], v12 offset:37120
    ds_read_b64_tr_b16 v[34:35], v13 offset:37120
    s_add_u32 m0, s49, 4096
    s_nop 0
    buffer_load_dwordx4 v5, s[36:39], s55 offen offset:0 nt lds
    s_waitcnt lgkmcnt(12)
    v_mfma_f32_32x32x16_bf16 v[224:239], v[40:43], v[84:87], v[224:239]
    ds_read_b64_tr_b16 v[36:37], v14 offset:37120
    ds_read_b64_tr_b16 v[38:39], v15 offset:37120
    buffer_load_dwordx4 v6, s[36:39], s55 offen offset:1024 nt lds
    s_waitcnt lgkmcnt(12)
    v_mfma_f32_32x32x16_bf16 v[240:255], v[44:47], v[84:87], v[240:255]
    ds_read_b64_tr_b16 v[40:41], v12 offset:43008
    ds_read_b64_tr_b16 v[42:43], v13 offset:43008
    s_mov_b32 m0, s62
    s_nop 0
    buffer_load_dwordx4 v1, s[40:43], s55 offen offset:0 nt lds
    s_waitcnt lgkmcnt(12)
    v_mfma_f32_32x32x16_bf16 v[160:175], v[48:51], v[88:91], v[160:175]
    ds_read_b64_tr_b16 v[44:45], v14 offset:43008
    ds_read_b64_tr_b16 v[46:47], v15 offset:43008
    buffer_load_dwordx4 v2, s[40:43], s55 offen offset:1024 nt lds
    s_waitcnt lgkmcnt(12)
    v_mfma_f32_32x32x16_bf16 v[176:191], v[52:55], v[88:91], v[176:191]
    ds_read_b64_tr_b16 v[48:49], v12 offset:43136
    ds_read_b64_tr_b16 v[50:51], v13 offset:43136
    buffer_load_dwordx4 v3, s[40:43], s55 offen offset:2048 nt lds
    s_waitcnt lgkmcnt(12)
    v_mfma_f32_32x32x16_bf16 v[192:207], v[56:59], v[88:91], v[192:207]
    ds_read_b64_tr_b16 v[52:53], v14 offset:43136
    ds_read_b64_tr_b16 v[54:55], v15 offset:43136
    buffer_load_dwordx4 v4, s[40:43], s55 offen offset:3072 nt lds
    s_waitcnt lgkmcnt(12)
    v_mfma_f32_32x32x16_bf16 v[208:223], v[60:63], v[88:91], v[208:223]
    ds_read_b64_tr_b16 v[56:57], v12 offset:43264
    ds_read_b64_tr_b16 v[58:59], v13 offset:43264
    s_add_u32 m0, s62, 4096
    s_nop 0
    buffer_load_dwordx4 v5, s[40:43], s55 offen offset:0 nt lds
    s_waitcnt lgkmcnt(12)
    v_mfma_f32_32x32x16_bf16 v[224:239], v[32:35], v[88:91], v[224:239]
    ds_read_b64_tr_b16 v[60:61], v14 offset:43264
    ds_read_b64_tr_b16 v[62:63], v15 offset:43264
    buffer_load_dwordx4 v6, s[40:43], s55 offen offset:1024 nt lds
    s_waitcnt lgkmcnt(12)
    v_mfma_f32_32x32x16_bf16 v[240:255], v[36:39], v[88:91], v[240:255]
    s_waitcnt lgkmcnt(10)
    v_mfma_f32_32x32x16_bf16 v[160:175], v[40:43], v[92:95], v[160:175]
    s_waitcnt lgkmcnt(8)
    v_mfma_f32_32x32x16_bf16 v[176:191], v[44:47], v[92:95], v[176:191]
    s_waitcnt lgkmcnt(6)
    v_mfma_f32_32x32x16_bf16 v[192:207], v[48:51], v[92:95], v[192:207]
    s_waitcnt lgkmcnt(4)
    v_mfma_f32_32x32x16_bf16 v[208:223], v[52:55], v[92:95], v[208:223]
    s_waitcnt lgkmcnt(2)
    v_mfma_f32_32x32x16_bf16 v[224:239], v[56:59], v[92:95], v[224:239]
    s_waitcnt lgkmcnt(0)
    v_mfma_f32_32x32x16_bf16 v[240:255], v[60:63], v[92:95], v[240:255]
    s_nop 7
    s_nop 7
    v_cvt_pk_bf16_f32 v112, v160, v161
    v_cvt_pk_bf16_f32 v113, v162, v163
    v_cvt_pk_bf16_f32 v114, v164, v165
    v_cvt_pk_bf16_f32 v115, v166, v167
    v_cvt_pk_bf16_f32 v116, v168, v169
    v_cvt_pk_bf16_f32 v117, v170, v171
    v_cvt_pk_bf16_f32 v118, v172, v173
    v_cvt_pk_bf16_f32 v119, v174, v175
    v_cvt_pk_bf16_f32 v120, v176, v177
    v_cvt_pk_bf16_f32 v121, v178, v179
    v_cvt_pk_bf16_f32 v122, v180, v181
    v_cvt_pk_bf16_f32 v123, v182, v183
    v_cvt_pk_bf16_f32 v124, v184, v185
    v_cvt_pk_bf16_f32 v125, v186, v187
    v_cvt_pk_bf16_f32 v126, v188, v189
    v_cvt_pk_bf16_f32 v127, v190, v191
    v_cvt_pk_bf16_f32 v128, v192, v193
    v_cvt_pk_bf16_f32 v129, v194, v195
    v_cvt_pk_bf16_f32 v130, v196, v197
    v_cvt_pk_bf16_f32 v131, v198, v199
    v_cvt_pk_bf16_f32 v132, v200, v201
    v_cvt_pk_bf16_f32 v133, v202, v203
    v_cvt_pk_bf16_f32 v134, v204, v205
    v_cvt_pk_bf16_f32 v135, v206, v207
    v_cvt_pk_bf16_f32 v136, v208, v209
    v_cvt_pk_bf16_f32 v137, v210, v211
    v_cvt_pk_bf16_f32 v138, v212, v213
    v_cvt_pk_bf16_f32 v139, v214, v215
    v_cvt_pk_bf16_f32 v140, v216, v217
    v_cvt_pk_bf16_f32 v141, v218, v219
    v_cvt_pk_bf16_f32 v142, v220, v221
    v_cvt_pk_bf16_f32 v143, v222, v223
    v_cvt_pk_bf16_f32 v144, v224, v225
    v_cvt_pk_bf16_f32 v145, v226, v227
    v_cvt_pk_bf16_f32 v146, v228, v229
    v_cvt_pk_bf16_f32 v147, v230, v231
    v_cvt_pk_bf16_f32 v148, v232, v233
    v_cvt_pk_bf16_f32 v149, v234, v235
    v_cvt_pk_bf16_f32 v150, v236, v237
    v_cvt_pk_bf16_f32 v151, v238, v239
    v_cvt_pk_bf16_f32 v152, v240, v241
    v_cvt_pk_bf16_f32 v153, v242, v243
    v_cvt_pk_bf16_f32 v154, v244, v245
    v_cvt_pk_bf16_f32 v155, v246, v247
    v_cvt_pk_bf16_f32 v156, v248, v249
    v_cvt_pk_bf16_f32 v157, v250, v251
    v_cvt_pk_bf16_f32 v158, v252, v253
    v_cvt_pk_bf16_f32 v159, v254, v255
    s_nop 1
    v_permlane32_swap_b32 v112, v114
    v_permlane32_swap_b32 v113, v115
    v_permlane32_swap_b32 v116, v118
    v_permlane32_swap_b32 v117, v119
    v_permlane32_swap_b32 v120, v122
    v_permlane32_swap_b32 v121, v123
    v_permlane32_swap_b32 v124, v126
    v_permlane32_swap_b32 v125, v127
    v_permlane32_swap_b32 v128, v130
    v_permlane32_swap_b32 v129, v131
    v_permlane32_swap_b32 v132, v134
    v_permlane32_swap_b32 v133, v135
    v_permlane32_swap_b32 v136, v138
    v_permlane32_swap_b32 v137, v139
    v_permlane32_swap_b32 v140, v142
    v_permlane32_swap_b32 v141, v143
    v_permlane32_swap_b32 v144, v146
    v_permlane32_swap_b32 v145, v147
    v_permlane32_swap_b32 v148, v150
    v_permlane32_swap_b32 v149, v151
    v_permlane32_swap_b32 v152, v154
    v_permlane32_swap_b32 v153, v155
    v_permlane32_swap_b32 v156, v158
    v_permlane32_swap_b32 v157, v159
    v_mov_b32 v30, 0xff800000
    v_mov_b32 v31, 0
    s_mov_b32 s62, 0
    s_mov_b32 s63, 49152
    s_mov_b32 s64, 24576
    s_mov_b32 s55, 24576
    s_mov_b32 s61, 0
attn_loop:
    s_cmp_eq_u32 s61, 7
    s_waitcnt vmcnt(6)
    s_barrier
    v_add_u32 v26, s62, v18
    v_add_u32 v27, s62, v19
    v_add_u32 v28, s62, v20
    v_add_u32 v29, s62, v21
    s_add_u32 s66, s49, s64
    s_add_u32 s67, s66, 4096
    s_cmp_eq_u32 s61, 7
    ds_read_b128 v[32:35], v26 offset:0
    ds_read_b128 v[36:39], v26 offset:12288
    ds_read_b128 v[40:43], v27 offset:0
    ds_read_b128 v[44:47], v27 offset:12288
    ds_read_b128 v[48:51], v28 offset:0
    ds_read_b128 v[52:55], v28 offset:12288
    ds_read_b128 v[56:59], v29 offset:0
    s_waitcnt lgkmcnt(6)
    v_mfma_f32_32x32x16_bf16 v[80:95], v[32:35], v[112:115], 0
    ds_read_b128 v[60:63], v29 offset:12288
    s_cbranch_scc1 attn_d0a
    s_mov_b32 m0, s66
    s_nop 0
    buffer_load_dwordx4 v1, s[36:39], s55 offen offset:0 nt lds
    buffer_load_dwordx4 v2, s[36:39], s55 offen offset:1024 nt lds
attn_d0a:
    s_waitcnt lgkmcnt(6)
    v_mfma_f32_32x32x16_bf16 v[96:111], v[36:39], v[112:115], 0
    ds_read_b128 v[32:35], v26 offset:128
    s_waitcnt lgkmcnt(6)
    v_mfma_f32_32x32x16_bf16 v[80:95], v[40:43], v[116:119], v[80:95]
    ds_read_b128 v[36:39], v26 offset:12416
    s_waitcnt lgkmcnt(6)
    v_mfma_f32_32x32x16_bf16 v[96:111], v[44:47], v[116:119], v[96:111]
    ds_read_b128 v[40:43], v27 offset:128
    s_cbranch_scc1 attn_d0b
    buffer_load_dwordx4 v3, s[36:39], s55 offen offset:2048 nt lds
    buffer_load_dwordx4 v4, s[36:39], s55 offen offset:3072 nt lds
attn_d0b:
    s_waitcnt lgkmcnt(6)
    v_mfma_f32_32x32x16_bf16 v[80:95], v[48:51], v[120:123], v[80:95]
    ds_read_b128 v[44:47], v27 offset:12416
    s_waitcnt lgkmcnt(6)
    v_mfma_f32_32x32x16_bf16 v[96:111], v[52:55], v[120:123], v[96:111]
    ds_read_b128 v[48:51], v28 offset:128
    s_waitcnt lgkmcnt(6)
    v_mfma_f32_32x32x16_bf16 v[80:95], v[56:59], v[124:127], v[80:95]
    ds_read_b128 v[52:55], v28 offset:12416
    s_cbranch_scc1 attn_d0c
    s_mov_b32 m0, s67
    s_nop 0
    buffer_load_dwordx4 v5, s[36:39], s55 offen offset:0 nt lds
    buffer_load_dwordx4 v6, s[36:39], s55 offen offset:1024 nt lds
attn_d0c:
    s_waitcnt lgkmcnt(6)
    v_mfma_f32_32x32x16_bf16 v[96:111], v[60:63], v[124:127], v[96:111]
    ds_read_b128 v[56:59], v29 offset:128
    s_waitcnt lgkmcnt(6)
    v_mfma_f32_32x32x16_bf16 v[80:95], v[32:35], v[128:131], v[80:95]
    ds_read_b128 v[60:63], v29 offset:12416
    s_waitcnt lgkmcnt(6)
    v_mfma_f32_32x32x16_bf16 v[96:111], v[36:39], v[128:131], v[96:111]
    ds_read_b128 v[32:35], v26 offset:256
    s_waitcnt lgkmcnt(6)
    v_mfma_f32_32x32x16_bf16 v[80:95], v[40:43], v[132:135], v[80:95]
    ds_read_b128 v[36:39], v26 offset:12544
    s_waitcnt lgkmcnt(6)
    v_mfma_f32_32x32x16_bf16 v[96:111], v[44:47], v[132:135], v[96:111]
    ds_read_b128 v[40:43], v27 offset:256
    s_waitcnt lgkmcnt(6)
    v_mfma_f32_32x32x16_bf16 v[80:95], v[48:51], v[136:139], v[80:95]
    ds_read_b128 v[44:47], v27 offset:12544
    s_waitcnt lgkmcnt(6)
    v_mfma_f32_32x32x16_bf16 v[96:111], v[52:55], v[136:139], v[96:111]
    ds_read_b128 v[48:51], v28 offset:256
    s_waitcnt lgkmcnt(6)
    v_mfma_f32_32x32x16_bf16 v[80:95], v[56:59], v[140:143], v[80:95]
    ds_read_b128 v[52:55], v28 offset:12544
    s_waitcnt lgkmcnt(6)
    v_mfma_f32_32x32x16_bf16 v[96:111], v[60:63], v[140:143], v[96:111]
    ds_read_b128 v[56:59], v29 offset:256
    s_waitcnt lgkmcnt(6)
    v_mfma_f32_32x32x16_bf16 v[80:95], v[32:35], v[144:147], v[80:95]
    ds_read_b128 v[60:63], v29 offset:12544
    s_waitcnt lgkmcnt(6)
    v_mfma_f32_32x32x16_bf16 v[96:111], v[36:39], v[144:147], v[96:111]
    s_waitcnt lgkmcnt(5)
    v_mfma_f32_32x32x16_bf16 v[80:95], v[40:43], v[148:151], v[80:95]
    s_waitcnt lgkmcnt(4)
    v_mfma_f32_32x32x16_bf16 v[96:111], v[44:47], v[148:151], v[96:111]
    s_waitcnt lgkmcnt(3)
    v_mfma_f32_32x32x16_bf16 v[80:95], v[48:51], v[152:155], v[80:95]
    s_waitcnt lgkmcnt(2)
    v_mfma_f32_32x32x16_bf16 v[96:111], v[52:55], v[152:155], v[96:111]
    s_waitcnt lgkmcnt(1)
    v_mfma_f32_32x32x16_bf16 v[80:95], v[56:59], v[156:159], v[80:95]
    s_waitcnt lgkmcnt(0)
    v_mfma_f32_32x32x16_bf16 v[96:111], v[60:63], v[156:159], v[96:111]
    s_nop 7
    s_nop 3
    v_max3_f32 v8, v80, v81, v82
    s_nop 0
    v_max3_f32 v9, v96, v97, v98
    v_max3_f32 v8, v8, v83, v84
    v_max3_f32 v9, v9, v99, v100
    v_max3_f32 v8, v8, v85, v86
    v_max3_f32 v9, v9, v101, v102
    v_max3_f32 v8, v8, v87, v88
    v_max3_f32 v9, v9, v103, v104
    v_max3_f32 v8, v8, v89, v90
    v_max3_f32 v9, v9, v105, v106
    v_max3_f32 v8, v8, v91, v92
    v_max3_f32 v9, v9, v107, v108
    v_max3_f32 v8, v8, v93, v94
    v_max3_f32 v9, v9, v109, v110
    v_max3_f32 v8, v8, v95, v111
    v_max3_f32 v8, v8, v9, v30
    s_nop 0
    v_mov_b32 v9, v8
    s_nop 1
    v_permlane32_swap_b32 v9, v8
    s_nop 1
    v_max_f32 v8, v8, v9
    v_sub_f32 v9, v30, v8
    v_mul_f32 v10, s59, v8
    v_mul_f32 v9, s59, v9
    v_mov_b32 v30, v8
    v_exp_f32 v12, v9
    v_fma_f32 v80, v80, s59, -v10
    v_fma_f32 v81, v81, s59, -v10
    v_exp_f32 v80, v80
    v_fma_f32 v82, v82, s59, -v10
    v_exp_f32 v81, v81
    v_fma_f32 v83, v83, s59, -v10
    v_exp_f32 v82, v82
    v_fma_f32 v84, v84, s59, -v10
    v_exp_f32 v83, v83
    v_fma_f32 v85, v85, s59, -v10
    v_exp_f32 v84, v84
    v_fma_f32 v86, v86, s59, -v10
    v_exp_f32 v85, v85
    v_fma_f32 v87, v87, s59, -v10
    v_exp_f32 v86, v86
    v_fma_f32 v88, v88, s59, -v10
    v_exp_f32 v87, v87
    v_fma_f32 v89, v89, s59, -v10
    v_exp_f32 v88, v88
    v_fma_f32 v90, v90, s59, -v10
    v_exp_f32 v89, v89
    v_fma_f32 v91, v91, s59, -v10
    v_exp_f32 v90, v90
    v_fma_f32 v92, v92, s59, -v10
    v_exp_f32 v91, v91
    v_fma_f32 v93, v93, s59, -v10
    v_exp_f32 v92, v92
    v_fma_f32 v94, v94, s59, -v10
    v_exp_f32 v93, v93
    v_fma_f32 v95, v95, s59, -v10
    v_exp_f32 v94, v94
    v_fma_f32 v96, v96, s59, -v10
    v_exp_f32 v95, v95
    v_fma_f32 v97, v97, s59, -v10
    v_exp_f32 v96, v96
    v_fma_f32 v98, v98, s59, -v10
    v_exp_f32 v97, v97
    v_fma_f32 v99, v99, s59, -v10
    v_exp_f32 v98, v98
    v_fma_f32 v100, v100, s59, -v10
    v_exp_f32 v99, v99
    v_fma_f32 v101, v101, s59, -v10
    v_exp_f32 v100, v100
    v_fma_f32 v102, v102, s59, -v10
    v_exp_f32 v101, v101
    v_fma_f32 v103, v103, s59, -v10
    v_exp_f32 v102, v102
    v_fma_f32 v104, v104, s59, -v10
    v_exp_f32 v103, v103
    v_fma_f32 v105, v105, s59, -v10
    v_exp_f32 v104, v104
    v_fma_f32 v106, v106, s59, -v10
    v_exp_f32 v105, v105
    v_fma_f32 v107, v107, s59, -v10
    v_exp_f32 v106, v106
    v_fma_f32 v108, v108, s59, -v10
    v_exp_f32 v107, v107
    v_fma_f32 v109, v109, s59, -v10
    v_exp_f32 v108, v108
    v_fma_f32 v110, v110, s59, -v10
    v_exp_f32 v109, v109
    v_fma_f32 v111, v111, s59, -v10
    v_exp_f32 v110, v110
    v_exp_f32 v111, v111
    v_pk_add_f32 v[14:15], v[80:81], v[82:83]
    v_pk_add_f32 v[16:17], v[84:85], v[86:87]
    v_pk_add_f32 v[14:15], v[14:15], v[88:89]
    v_pk_add_f32 v[16:17], v[16:17], v[90:91]
    v_pk_add_f32 v[14:15], v[14:15], v[92:93]
    v_pk_add_f32 v[16:17], v[16:17], v[94:95]
    v_pk_add_f32 v[14:15], v[14:15], v[96:97]
    v_pk_add_f32 v[16:17], v[16:17], v[98:99]
    v_pk_add_f32 v[14:15], v[14:15], v[100:101]
    v_pk_add_f32 v[16:17], v[16:17], v[102:103]
    v_pk_add_f32 v[14:15], v[14:15], v[104:105]
    v_pk_add_f32 v[16:17], v[16:17], v[106:107]
    v_pk_add_f32 v[14:15], v[14:15], v[108:109]
    v_pk_add_f32 v[16:17], v[16:17], v[110:111]
    v_cvt_pk_bf16_f32 v64, v80, v81
    v_cvt_pk_bf16_f32 v65, v82, v83
    v_cvt_pk_bf16_f32 v66, v84, v85
    v_cvt_pk_bf16_f32 v67, v86, v87
    v_cvt_pk_bf16_f32 v68, v88, v89
    v_cvt_pk_bf16_f32 v69, v90, v91
    v_cvt_pk_bf16_f32 v70, v92, v93
    v_cvt_pk_bf16_f32 v71, v94, v95
    v_cvt_pk_bf16_f32 v72, v96, v97
    v_cvt_pk_bf16_f32 v73, v98, v99
    v_cvt_pk_bf16_f32 v74, v100, v101
    v_cvt_pk_bf16_f32 v75, v102, v103
    v_cvt_pk_bf16_f32 v76, v104, v105
    v_cvt_pk_bf16_f32 v77, v106, v107
    v_cvt_pk_bf16_f32 v78, v108, v109
    v_cvt_pk_bf16_f32 v79, v110, v111
    v_pk_add_f32 v[14:15], v[14:15], v[16:17]
    s_nop 0
    v_add_f32 v14, v14, v15
    s_nop 0
    v_fma_f32 v31, v31, v12, v14
    s_mov_b32 s68, s62
    s_mov_b32 s62, s63
    s_mov_b32 s63, s64
    s_mov_b32 s64, s68
    s_cmp_eq_u32 s61, 7
    s_cbranch_scc0 attn_w6
    s_waitcnt vmcnt(0)
attn_w6:
    s_waitcnt vmcnt(6)
    s_barrier
    v_add_u32 v26, s62, v22
    v_add_u32 v27, s62, v23
    v_add_u32 v28, s62, v24
    v_add_u32 v29, s62, v25
    s_add_u32 s66, s49, s64
    s_add_u32 s67, s66, 4096
    s_cmp_eq_u32 s61, 7
    ds_read_b64_tr_b16 v[32:33], v26 offset:0
    ds_read_b64_tr_b16 v[34:35], v27 offset:0
    ds_read_b64_tr_b16 v[36:37], v28 offset:0
    ds_read_b64_tr_b16 v[38:39], v29 offset:0
    ds_read_b64_tr_b16 v[40:41], v26 offset:128
    ds_read_b64_tr_b16 v[42:43], v27 offset:128
    ds_read_b64_tr_b16 v[44:45], v28 offset:128
    ds_read_b64_tr_b16 v[46:47], v29 offset:128
    ds_read_b64_tr_b16 v[48:49], v26 offset:256
    ds_read_b64_tr_b16 v[50:51], v27 offset:256
    ds_read_b64_tr_b16 v[52:53], v28 offset:256
    ds_read_b64_tr_b16 v[54:55], v29 offset:256
    ds_read_b64_tr_b16 v[56:57], v26 offset:6144
    ds_read_b64_tr_b16 v[58:59], v27 offset:6144
    s_cbranch_scc1 attn_d1a
    s_mov_b32 m0, s66
    s_nop 0
    buffer_load_dwordx4 v1, s[40:43], s55 offen offset:0 nt lds
    buffer_load_dwordx4 v2, s[40:43], s55 offen offset:1024 nt lds
attn_d1a:
    v_pk_mul_f32 v[160:161], v[160:161], v[12:13] op_sel_hi:[1,0]
    v_pk_mul_f32 v[162:163], v[162:163], v[12:13] op_sel_hi:[1,0]
    v_pk_mul_f32 v[164:165], v[164:165], v[12:13] op_sel_hi:[1,0]
    v_pk_mul_f32 v[166:167], v[166:167], v[12:13] op_sel_hi:[1,0]
    v_pk_mul_f32 v[168:169], v[168:169], v[12:13] op_sel_hi:[1,0]
    v_pk_mul_f32 v[170:171], v[170:171], v[12:13] op_sel_hi:[1,0]
    v_pk_mul_f32 v[172:173], v[172:173], v[12:13] op_sel_hi:[1,0]
    v_pk_mul_f32 v[174:175], v[174:175], v[12:13] op_sel_hi:[1,0]
    v_pk_mul_f32 v[176:177], v[176:177], v[12:13] op_sel_hi:[1,0]
    v_pk_mul_f32 v[178:179], v[178:179], v[12:13] op_sel_hi:[1,0]
    v_pk_mul_f32 v[180:181], v[180:181], v[12:13] op_sel_hi:[1,0]
    v_pk_mul_f32 v[182:183], v[182:183], v[12:13] op_sel_hi:[1,0]
    v_pk_mul_f32 v[184:185], v[184:185], v[12:13] op_sel_hi:[1,0]
    v_pk_mul_f32 v[186:187], v[186:187], v[12:13] op_sel_hi:[1,0]
    v_pk_mul_f32 v[188:189], v[188:189], v[12:13] op_sel_hi:[1,0]
    v_pk_mul_f32 v[190:191], v[190:191], v[12:13] op_sel_hi:[1,0]
    v_pk_mul_f32 v[192:193], v[192:193], v[12:13] op_sel_hi:[1,0]
    v_pk_mul_f32 v[194:195], v[194:195], v[12:13] op_sel_hi:[1,0]
    v_pk_mul_f32 v[196:197], v[196:197], v[12:13] op_sel_hi:[1,0]
    v_pk_mul_f32 v[198:199], v[198:199], v[12:13] op_sel_hi:[1,0]
    v_pk_mul_f32 v[200:201], v[200:201], v[12:13] op_sel_hi:[1,0]
    v_pk_mul_f32 v[202:203], v[202:203], v[12:13] op_sel_hi:[1,0]
    v_pk_mul_f32 v[204:205], v[204:205], v[12:13] op_sel_hi:[1,0]
    v_pk_mul_f32 v[206:207], v[206:207], v[12:13] op_sel_hi:[1,0]
    s_cbranch_scc1 attn_d1b
    buffer_load_dwordx4 v3, s[40:43], s55 offen offset:2048 nt lds
    buffer_load_dwordx4 v4, s[40:43], s55 offen offset:3072 nt lds
attn_d1b:
    v_pk_mul_f32 v[208:209], v[208:209], v[12:13] op_sel_hi:[1,0]
    v_pk_mul_f32 v[210:211], v[210:211], v[12:13] op_sel_hi:[1,0]
    v_pk_mul_f32 v[212:213], v[212:213], v[12:13] op_sel_hi:[1,0]
    v_pk_mul_f32 v[214:215], v[214:215], v[12:13] op_sel_hi:[1,0]
    v_pk_mul_f32 v[216:217], v[216:217], v[12:13] op_sel_hi:[1,0]
    v_pk_mul_f32 v[218:219], v[218:219], v[12:13] op_sel_hi:[1,0]
    v_pk_mul_f32 v[220:221], v[220:221], v[12:13] op_sel_hi:[1,0]
    v_pk_mul_f32 v[222:223], v[222:223], v[12:13] op_sel_hi:[1,0]
    v_pk_mul_f32 v[224:225], v[224:225], v[12:13] op_sel_hi:[1,0]
    v_pk_mul_f32 v[226:227], v[226:227], v[12:13] op_sel_hi:[1,0]
    v_pk_mul_f32 v[228:229], v[228:229], v[12:13] op_sel_hi:[1,0]
    v_pk_mul_f32 v[230:231], v[230:231], v[12:13] op_sel_hi:[1,0]
    v_pk_mul_f32 v[232:233], v[232:233], v[12:13] op_sel_hi:[1,0]
    v_pk_mul_f32 v[234:235], v[234:235], v[12:13] op_sel_hi:[1,0]
    v_pk_mul_f32 v[236:237], v[236:237], v[12:13] op_sel_hi:[1,0]
    v_pk_mul_f32 v[238:239], v[238:239], v[12:13] op_sel_hi:[1,0]
    v_pk_mul_f32 v[240:241], v[240:241], v[12:13] op_sel_hi:[1,0]
    v_pk_mul_f32 v[242:243], v[242:243], v[12:13] op_sel_hi:[1,0]
    v_pk_mul_f32 v[244:245], v[244:245], v[12:13] op_sel_hi:[1,0]
    v_pk_mul_f32 v[246:247], v[246:247], v[12:13] op_sel_hi:[1,0]
    v_pk_mul_f32 v[248:249], v[248:249], v[12:13] op_sel_hi:[1,0]
    v_pk_mul_f32 v[250:251], v[250:251], v[12:13] op_sel_hi:[1,0]
    v_pk_mul_f32 v[252:253], v[252:253], v[12:13] op_sel_hi:[1,0]
    v_pk_mul_f32 v[254:255], v[254:255], v[12:13] op_sel_hi:[1,0]
    s_cbranch_scc1 attn_d1c
    s_mov_b32 m0, s67
    s_nop 0
    buffer_load_dwordx4 v5, s[40:43], s55 offen offset:0 nt lds
    buffer_load_dwordx4 v6, s[40:43], s55 offen offset:1024 nt lds
attn_d1c:
    s_nop 1
    s_waitcnt lgkmcnt(12)
    v_mfma_f32_32x32x16_bf16 v[160:175], v[32:35], v[64:67], v[160:175]
    ds_read_b64_tr_b16 v[60:61], v28 offset:6144
    ds_read_b64_tr_b16 v[62:63], v29 offset:6144
    s_waitcnt lgkmcnt(12)
    v_mfma_f32_32x32x16_bf16 v[176:191], v[36:39], v[64:67], v[176:191]
    ds_read_b64_tr_b16 v[32:33], v26 offset:6272
    ds_read_b64_tr_b16 v[34:35], v27 offset:6272
    s_waitcnt lgkmcnt(12)
    v_mfma_f32_32x32x16_bf16 v[192:207], v[40:43], v[64:67], v[192:207]
    ds_read_b64_tr_b16 v[36:37], v28 offset:6272
    ds_read_b64_tr_b16 v[38:39], v29 offset:6272
    s_waitcnt lgkmcnt(12)
    v_mfma_f32_32x32x16_bf16 v[208:223], v[44:47], v[64:67], v[208:223]
    ds_read_b64_tr_b16 v[40:41], v26 offset:6400
    ds_read_b64_tr_b16 v[42:43], v27 offset:6400
    s_waitcnt lgkmcnt(12)
    v_mfma_f32_32x32x16_bf16 v[224:239], v[48:51], v[64:67], v[224:239]
    ds_read_b64_tr_b16 v[44:45], v28 offset:6400
    ds_read_b64_tr_b16 v[46:47], v29 offset:6400
    s_waitcnt lgkmcnt(12)
    v_mfma_f32_32x32x16_bf16 v[240:255], v[52:55], v[64:67], v[240:255]
    ds_read_b64_tr_b16 v[48:49], v26 offset:12288
    ds_read_b64_tr_b16 v[50:51], v27 offset:12288
    s_waitcnt lgkmcnt(12)
    v_mfma_f32_32x32x16_bf16 v[160:175], v[56:59], v[68:71], v[160:175]
    ds_read_b64_tr_b16 v[52:53], v28 offset:12288
    ds_read_b64_tr_b16 v[54:55], v29 offset:12288
    s_waitcnt lgkmcnt(12)
    v_mfma_f32_32x32x16_bf16 v[176:191], v[60:63], v[68:71], v[176:191]
    ds_read_b64_tr_b16 v[56:57], v26 offset:12416
    ds_read_b64_tr_b16 v[58:59], v27 offset:12416
    s_waitcnt lgkmcnt(12)
    v_mfma_f32_32x32x16_bf16 v[192:207], v[32:35], v[68:71], v[192:207]
    ds_read_b64_tr_b16 v[60:61], v28 offset:12416
    ds_read_b64_tr_b16 v[62:63], v29 offset:12416
    s_waitcnt lgkmcnt(12)
    v_mfma_f32_32x32x16_bf16 v[208:223], v[36:39], v[68:71], v[208:223]
    ds_read_b64_tr_b16 v[32:33], v26 offset:12544
    ds_read_b64_tr_b16 v[34:35], v27 offset:12544
    s_waitcnt lgkmcnt(12)
    v_mfma_f32_32x32x16_bf16 v[224:239], v[40:43], v[68:71], v[224:239]
    ds_read_b64_tr_b16 v[36:37], v28 offset:12544
    ds_read_b64_tr_b16 v[38:39], v29 offset:12544
    s_waitcnt lgkmcnt(12)
    v_mfma_f32_32x32x16_bf16 v[240:255], v[44:47], v[68:71], v[240:255]
    ds_read_b64_tr_b16 v[40:41], v26 offset:18432
    ds_read_b64_tr_b16 v[42:43], v27 offset:18432
    s_waitcnt lgkmcnt(12)
    v_mfma_f32_32x32x16_bf16 v[160:175], v[48:51], v[72:75], v[160:175]
    ds_read_b64_tr_b16 v[44:45], v28 offset:18432
    ds_read_b64_tr_b16 v[46:47], v29 offset:18432
    s_waitcnt lgkmcnt(12)
    v_mfma_f32_32x32x16_bf16 v[176:191], v[52:55], v[72:75], v[176:191]
    ds_read_b64_tr_b16 v[48:49], v26 offset:18560
    ds_read_b64_tr_b16 v[50:51], v27 offset:18560
    s_waitcnt lgkmcnt(12)
    v_mfma_f32_32x32x16_bf16 v[192:207], v[56:59], v[72:75], v[192:207]
    ds_read_b64_tr_b16 v[52:53], v28 offset:18560
    ds_read_b64_tr_b16 v[54:55], v29 offset:18560
    s_waitcnt lgkmcnt(12)
    v_mfma_f32_32x32x16_bf16 v[208:223], v[60:63], v[72:75], v[208:223]
    ds_read_b64_tr_b16 v[56:57], v26 offset:18688
    ds_read_b64_tr_b16 v[58:59], v27 offset:18688
    s_waitcnt lgkmcnt(12)
    v_mfma_f32_32x32x16_bf16 v[224:239], v[32:35], v[72:75], v[224:239]
    ds_read_b64_tr_b16 v[60:61], v28 offset:18688
    ds_read_b64_tr_b16 v[62:63], v29 offset:18688
    s_waitcnt lgkmcnt(12)
    v_mfma_f32_32x32x16_bf16 v[240:255], v[36:39], v[72:75], v[240:255]
    s_waitcnt lgkmcnt(10)
    v_mfma_f32_32x32x16_bf16 v[160:175], v[40:43], v[76:79], v[160:175]
    s_waitcnt lgkmcnt(8)
    v_mfma_f32_32x32x16_bf16 v[176:191], v[44:47], v[76:79], v[176:191]
    s_waitcnt lgkmcnt(6)
    v_mfma_f32_32x32x16_bf16 v[192:207], v[48:51], v[76:79], v[192:207]
    s_waitcnt lgkmcnt(4)
    v_mfma_f32_32x32x16_bf16 v[208:223], v[52:55], v[76:79], v[208:223]
    s_waitcnt lgkmcnt(2)
    v_mfma_f32_32x32x16_bf16 v[224:239], v[56:59], v[76:79], v[224:239]
    s_waitcnt lgkmcnt(0)
    v_mfma_f32_32x32x16_bf16 v[240:255], v[60:63], v[76:79], v[240:255]
    s_add_u32 s55, s55, 24576
    s_mov_b32 s68, s62
    s_mov_b32 s62, s63
    s_mov_b32 s63, s64
    s_mov_b32 s64, s68
    s_add_u32 s61, s61, 1
    s_cmp_lt_u32 s61, 8
    s_cbranch_scc1 attn_loop
    v_mov_b32 v9, v31
    v_mov_b32 v8, v31
    s_nop 1
    v_permlane32_swap_b32 v9, v8
    s_nop 1
    v_add_f32 v8, v8, v9
    s_nop 0
    v_rcp_f32 v12, v8
    v_and_b32 v1, 31, v0
    v_lshrrev_b32 v2, 5, v0
    v_bfe_u32 v3, v1, 1, 3
    v_xor_b32 v3, v3, v2
    v_lshlrev_b32 v3, 4, v3
    v_lshl_add_u32 v3, v1, 7, v3
    s_lshl_b32 s52, s48, 12
    v_add_u32 v14, s52, v3
    v_xor_b32 v15, 32, v14
    v_xor_b32 v16, 64, v14
    v_xor_b32 v17, 96, v14
    s_nop 7
    v_pk_mul_f32 v[160:161], v[160:161], v[12:13] op_sel_hi:[1,0]
    v_pk_mul_f32 v[162:163], v[162:163], v[12:13] op_sel_hi:[1,0]
    v_pk_mul_f32 v[164:165], v[164:165], v[12:13] op_sel_hi:[1,0]
    v_pk_mul_f32 v[166:167], v[166:167], v[12:13] op_sel_hi:[1,0]
    v_pk_mul_f32 v[168:169], v[168:169], v[12:13] op_sel_hi:[1,0]
    v_pk_mul_f32 v[170:171], v[170:171], v[12:13] op_sel_hi:[1,0]
    v_pk_mul_f32 v[172:173], v[172:173], v[12:13] op_sel_hi:[1,0]
    v_pk_mul_f32 v[174:175], v[174:175], v[12:13] op_sel_hi:[1,0]
    v_pk_mul_f32 v[176:177], v[176:177], v[12:13] op_sel_hi:[1,0]
    v_pk_mul_f32 v[178:179], v[178:179], v[12:13] op_sel_hi:[1,0]
    v_pk_mul_f32 v[180:181], v[180:181], v[12:13] op_sel_hi:[1,0]
    v_pk_mul_f32 v[182:183], v[182:183], v[12:13] op_sel_hi:[1,0]
    v_pk_mul_f32 v[184:185], v[184:185], v[12:13] op_sel_hi:[1,0]
    v_pk_mul_f32 v[186:187], v[186:187], v[12:13] op_sel_hi:[1,0]
    v_pk_mul_f32 v[188:189], v[188:189], v[12:13] op_sel_hi:[1,0]
    v_pk_mul_f32 v[190:191], v[190:191], v[12:13] op_sel_hi:[1,0]
    v_pk_mul_f32 v[192:193], v[192:193], v[12:13] op_sel_hi:[1,0]
    v_pk_mul_f32 v[194:195], v[194:195], v[12:13] op_sel_hi:[1,0]
    v_pk_mul_f32 v[196:197], v[196:197], v[12:13] op_sel_hi:[1,0]
    v_pk_mul_f32 v[198:199], v[198:199], v[12:13] op_sel_hi:[1,0]
    v_pk_mul_f32 v[200:201], v[200:201], v[12:13] op_sel_hi:[1,0]
    v_pk_mul_f32 v[202:203], v[202:203], v[12:13] op_sel_hi:[1,0]
    v_pk_mul_f32 v[204:205], v[204:205], v[12:13] op_sel_hi:[1,0]
    v_pk_mul_f32 v[206:207], v[206:207], v[12:13] op_sel_hi:[1,0]
    v_pk_mul_f32 v[208:209], v[208:209], v[12:13] op_sel_hi:[1,0]
    v_pk_mul_f32 v[210:211], v[210:211], v[12:13] op_sel_hi:[1,0]
    v_pk_mul_f32 v[212:213], v[212:213], v[12:13] op_sel_hi:[1,0]
    v_pk_mul_f32 v[214:215], v[214:215], v[12:13] op_sel_hi:[1,0]
    v_pk_mul_f32 v[216:217], v[216:217], v[12:13] op_sel_hi:[1,0]
    v_pk_mul_f32 v[218:219], v[218:219], v[12:13] op_sel_hi:[1,0]
    v_pk_mul_f32 v[220:221], v[220:221], v[12:13] op_sel_hi:[1,0]
    v_pk_mul_f32 v[222:223], v[222:223], v[12:13] op_sel_hi:[1,0]
    v_pk_mul_f32 v[224:225], v[224:225], v[12:13] op_sel_hi:[1,0]
    v_pk_mul_f32 v[226:227], v[226:227], v[12:13] op_sel_hi:[1,0]
    v_pk_mul_f32 v[228:229], v[228:229], v[12:13] op_sel_hi:[1,0]
    v_pk_mul_f32 v[230:231], v[230:231], v[12:13] op_sel_hi:[1,0]
    v_pk_mul_f32 v[232:233], v[232:233], v[12:13] op_sel_hi:[1,0]
    v_pk_mul_f32 v[234:235], v[234:235], v[12:13] op_sel_hi:[1,0]
    v_pk_mul_f32 v[236:237], v[236:237], v[12:13] op_sel_hi:[1,0]
    v_pk_mul_f32 v[238:239], v[238:239], v[12:13] op_sel_hi:[1,0]
    v_pk_mul_f32 v[240:241], v[240:241], v[12:13] op_sel_hi:[1,0]
    v_pk_mul_f32 v[242:243], v[242:243], v[12:13] op_sel_hi:[1,0]
    v_pk_mul_f32 v[244:245], v[244:245], v[12:13] op_sel_hi:[1,0]
    v_pk_mul_f32 v[246:247], v[246:247], v[12:13] op_sel_hi:[1,0]
    v_pk_mul_f32 v[248:249], v[248:249], v[12:13] op_sel_hi:[1,0]
    v_pk_mul_f32 v[250:251], v[250:251], v[12:13] op_sel_hi:[1,0]
    v_pk_mul_f32 v[252:253], v[252:253], v[12:13] op_sel_hi:[1,0]
    v_pk_mul_f32 v[254:255], v[254:255], v[12:13] op_sel_hi:[1,0]
    v_cvt_pk_bf16_f32 v64, v160, v161
    v_cvt_pk_bf16_f32 v65, v162, v163
    v_cvt_pk_bf16_f32 v66, v164, v165
    v_cvt_pk_bf16_f32 v67, v166, v167
    v_cvt_pk_bf16_f32 v68, v168, v169
    v_cvt_pk_bf16_f32 v69, v170, v171
    v_cvt_pk_bf16_f32 v70, v172, v173
    v_cvt_pk_bf16_f32 v71, v174, v175
    v_cvt_pk_bf16_f32 v72, v176, v177
    v_cvt_pk_bf16_f32 v73, v178, v179
    v_cvt_pk_bf16_f32 v74, v180, v181
    v_cvt_pk_bf16_f32 v75, v182, v183
    v_cvt_pk_bf16_f32 v76, v184, v185
    v_cvt_pk_bf16_f32 v77, v186, v187
    v_cvt_pk_bf16_f32 v78, v188, v189
    v_cvt_pk_bf16_f32 v79, v190, v191
    v_cvt_pk_bf16_f32 v80, v192, v193
    v_cvt_pk_bf16_f32 v81, v194, v195
    v_cvt_pk_bf16_f32 v82, v196, v197
    v_cvt_pk_bf16_f32 v83, v198, v199
    v_cvt_pk_bf16_f32 v84, v200, v201
    v_cvt_pk_bf16_f32 v85, v202, v203
    v_cvt_pk_bf16_f32 v86, v204, v205
    v_cvt_pk_bf16_f32 v87, v206, v207
    v_cvt_pk_bf16_f32 v88, v208, v209
    v_cvt_pk_bf16_f32 v89, v210, v211
    v_cvt_pk_bf16_f32 v90, v212, v213
    v_cvt_pk_bf16_f32 v91, v214, v215
    v_cvt_pk_bf16_f32 v92, v216, v217
    v_cvt_pk_bf16_f32 v93, v218, v219
    v_cvt_pk_bf16_f32 v94, v220, v221
    v_cvt_pk_bf16_f32 v95, v222, v223
    v_cvt_pk_bf16_f32 v96, v224, v225
    v_cvt_pk_bf16_f32 v97, v226, v227
    v_cvt_pk_bf16_f32 v98, v228, v229
    v_cvt_pk_bf16_f32 v99, v230, v231
    v_cvt_pk_bf16_f32 v100, v232, v233
    v_cvt_pk_bf16_f32 v101, v234, v235
    v_cvt_pk_bf16_f32 v102, v236, v237
    v_cvt_pk_bf16_f32 v103, v238, v239
    v_cvt_pk_bf16_f32 v104, v240, v241
    v_cvt_pk_bf16_f32 v105, v242, v243
    v_cvt_pk_bf16_f32 v106, v244, v245
    v_cvt_pk_bf16_f32 v107, v246, v247
    v_cvt_pk_bf16_f32 v108, v248, v249
    v_cvt_pk_bf16_f32 v109, v250, v251
    v_cvt_pk_bf16_f32 v110, v252, v253
    v_cvt_pk_bf16_f32 v111, v254, v255
    s_nop 1
    v_permlane32_swap_b32 v64, v66
    v_permlane32_swap_b32 v65, v67
    v_permlane32_swap_b32 v68, v70
    v_permlane32_swap_b32 v69, v71
    v_permlane32_swap_b32 v72, v74
    v_permlane32_swap_b32 v73, v75
    v_permlane32_swap_b32 v76, v78
    v_permlane32_swap_b32 v77, v79
    v_permlane32_swap_b32 v80, v82
    v_permlane32_swap_b32 v81, v83
    v_permlane32_swap_b32 v84, v86
    v_permlane32_swap_b32 v85, v87
    v_permlane32_swap_b32 v88, v90
    v_permlane32_swap_b32 v89, v91
    v_permlane32_swap_b32 v92, v94
    v_permlane32_swap_b32 v93, v95
    v_permlane32_swap_b32 v96, v98
    v_permlane32_swap_b32 v97, v99
    v_permlane32_swap_b32 v100, v102
    v_permlane32_swap_b32 v101, v103
    v_permlane32_swap_b32 v104, v106
    v_permlane32_swap_b32 v105, v107
    v_permlane32_swap_b32 v108, v110
    v_permlane32_swap_b32 v109, v111
    s_mov_b32 s53, 16384
    s_mov_b32 s54, 32768
    s_nop 1
    buffer_store_dwordx4 v[64:67], v14, s[44:47], 0 offen
    buffer_store_dwordx4 v[68:71], v15, s[44:47], 0 offen
    buffer_store_dwordx4 v[72:75], v16, s[44:47], 0 offen
    buffer_store_dwordx4 v[76:79], v17, s[44:47], 0 offen
    buffer_store_dwordx4 v[80:83], v14, s[44:47], s53 offen
    buffer_store_dwordx4 v[84:87], v15, s[44:47], s53 offen
    buffer_store_dwordx4 v[88:91], v16, s[44:47], s53 offen
    buffer_store_dwordx4 v[92:95], v17, s[44:47], s53 offen
    buffer_store_dwordx4 v[96:99], v14, s[44:47], s54 offen
    buffer_store_dwordx4 v[100:103], v15, s[44:47], s54 offen
    buffer_store_dwordx4 v[104:107], v16, s[44:47], s54 offen
    buffer_store_dwordx4 v[108:111], v17, s[44:47], s54 offen
attn_exit:
    s_endpgm
.globl oproj_kernel
.p2align 8
.type oproj_kernel,@function
oproj_kernel:
    s_cmp_ge_u32 s2, 256
    s_cbranch_scc1 oproj_exit
    s_load_dwordx2 s[4:5], s[0:1], 32
    s_load_dwordx2 s[6:7], s[0:1], 72
    s_load_dwordx2 s[24:25], s[0:1], 96
    v_lshrrev_b32 v1, 6, v0
    s_nop 1
    v_readfirstlane_b32 s48, v1
    v_and_b32 v0, 63, v0
    s_and_b32 s52, s2, 7
    s_lshr_b32 s58, s52, 2
    s_and_b32 s57, s52, 3
    s_lshr_b32 s53, s2, 3
    s_lshr_b32 s56, s53, 2
    s_and_b32 s55, s53, 3
    s_lshl_b32 s52, s48, 12
    v_lshlrev_b32 v1, 4, v0
    v_add_u32 v1, s52, v1
    s_mul_i32 s52, s48, 320
    v_add_u32 v40, s52, v0
    v_mul_u32_u24 v41, 0xccd, v40
    v_lshrrev_b32 v41, 16, v41
    v_mul_u32_u24 v42, 20, v41
    v_sub_u32 v42, v40, v42
    v_lshlrev_b32 v42, 4, v42
    v_mul_u32_u24 v41, 0x500, v41
    v_add_u32 v42, v41, v42
    v_mov_b32 v2, v42
    v_add_u32 v40, s52, v0
    v_add_u32 v40, 64, v40
    v_mul_u32_u24 v41, 0xccd, v40
    v_lshrrev_b32 v41, 16, v41
    v_mul_u32_u24 v42, 20, v41
    v_sub_u32 v42, v40, v42
    v_lshlrev_b32 v42, 4, v42
    v_mul_u32_u24 v41, 0x500, v41
    v_add_u32 v42, v41, v42
    v_subrev_u32 v42, 1024, v42
    v_mov_b32 v3, v42
    v_add_u32 v40, s52, v0
    v_add_u32 v40, 128, v40
    v_mul_u32_u24 v41, 0xccd, v40
    v_lshrrev_b32 v41, 16, v41
    v_mul_u32_u24 v42, 20, v41
    v_sub_u32 v42, v40, v42
    v_lshlrev_b32 v42, 4, v42
    v_mul_u32_u24 v41, 0x500, v41
    v_add_u32 v42, v41, v42
    v_subrev_u32 v42, 2048, v42
    v_mov_b32 v4, v42
    v_add_u32 v40, s52, v0
    v_add_u32 v40, 192, v40
    v_mul_u32_u24 v41, 0xccd, v40
    v_lshrrev_b32 v41, 16, v41
    v_mul_u32_u24 v42, 20, v41
    v_sub_u32 v42, v40, v42
    v_lshlrev_b32 v42, 4, v42
    v_mul_u32_u24 v41, 0x500, v41
    v_add_u32 v42, v41, v42
    v_subrev_u32 v42, 3072, v42
    v_mov_b32 v5, v42
    v_add_u32 v40, s52, v0
    v_add_u32 v40, 256, v40
    v_mul_u32_u24 v41, 0xccd, v40
    v_lshrrev_b32 v41, 16, v41
    v_mul_u32_u24 v42, 20, v41
    v_sub_u32 v42, v40, v42
    v_lshlrev_b32 v42, 4, v42
    v_mul_u32_u24 v41, 0x500, v41
    v_add_u32 v42, v41, v42
    v_mov_b32 v6, v42
    s_waitcnt lgkmcnt(0)
    s_cmp_eq_u32 s58, 0
    s_cselect_b32 s4, s4, s6
    s_cselect_b32 s5, s5, s7
    s_mul_i32 s52, s57, 1966080
    s_mul_i32 s53, s55, 320
    s_add_u32 s52, s52, s53
    s_add_u32 s4, s4, s52
    s_addc_u32 s5, s5, 0
    s_sub_u32 s53, 7864320, s52
    s_mov_b32 s32, s4
    s_and_b32 s33, s5, 0xffff
    s_mov_b32 s34, s53
    s_mov_b32 s35, 0x00020000
    s_lshl_b32 s52, s58, 3
    s_add_u32 s52, s52, s56
    s_mul_i32 s52, s52, 96
    s_mul_i32 s53, s57, 24
    s_add_u32 s52, s52, s53
    s_lshl_b32 s52, s52, 14
    s_add_u32 s8, s24, s52
    s_addc_u32 s9, s25, 0
    s_mov_b32 s28, s8
    s_and_b32 s29, s9, 0xffff
    s_mov_b32 s30, 393216
    s_mov_b32 s31, 0x00020000
    s_lshl_b32 s52, s58, 3
    s_add_u32 s52, s52, s56
    s_lshl_b32 s52, s52, 2
    s_add_u32 s52, s52, s55
    s_lshl_b32 s52, s52, 2
    s_add_u32 s52, s52, s57
    s_mul_i32 s52, s52, 40960
    s_add_u32 s52, s52, 33554432
    s_add_u32 s24, s24, s52
    s_addc_u32 s25, s25, 0
    s_mov_b32 s44, s24
    s_and_b32 s45, s25, 0xffff
    s_mov_b32 s46, 40960
    s_mov_b32 s47, 0x00020000
    s_lshl_b32 s49, s48, 12
    s_mul_i32 s50, s48, 5120
    s_add_u32 s50, s50, 16384
    s_mov_b32 s53, 0
    s_mov_b32 s54, 0
    s_add_u32 m0, s49, 0
    s_nop 0
    buffer_load_dwordx4 v1, s[28:31], s53 offen lds
    buffer_load_dwordx4 v1, s[28:31], s53 offen offset:1024 lds
    buffer_load_dwordx4 v1, s[28:31], s53 offen offset:2048 lds
    buffer_load_dwordx4 v1, s[28:31], s53 offen offset:3072 lds
    s_add_u32 s53, s53, 16384
    s_add_u32 m0, s50, 0
    s_nop 0
    buffer_load_dwordx4 v2, s[32:35], s54 offen lds
    buffer_load_dwordx4 v3, s[32:35], s54 offen offset:1024 lds
    buffer_load_dwordx4 v4, s[32:35], s54 offen offset:2048 lds
    buffer_load_dwordx4 v5, s[32:35], s54 offen offset:3072 lds
    s_add_u32 m0, s50, 4096
    s_nop 0
    buffer_load_dwordx4 v6, s[32:35], s54 offen lds
    s_add_u32 s54, s54, 81920
    s_add_u32 m0, s49, 36864
    s_nop 0
    buffer_load_dwordx4 v1, s[28:31], s53 offen lds
    buffer_load_dwordx4 v1, s[28:31], s53 offen offset:1024 lds
    buffer_load_dwordx4 v1, s[28:31], s53 offen offset:2048 lds
    buffer_load_dwordx4 v1, s[28:31], s53 offen offset:3072 lds
    s_add_u32 s53, s53, 16384
    s_add_u32 m0, s50, 36864
    s_nop 0
    buffer_load_dwordx4 v2, s[32:35], s54 offen lds
    buffer_load_dwordx4 v3, s[32:35], s54 offen offset:1024 lds
    buffer_load_dwordx4 v4, s[32:35], s54 offen offset:2048 lds
    buffer_load_dwordx4 v5, s[32:35], s54 offen offset:3072 lds
    s_add_u32 m0, s50, 40960
    s_nop 0
    buffer_load_dwordx4 v6, s[32:35], s54 offen lds
    s_add_u32 s54, s54, 81920
    v_lshrrev_b32 v46, 5, v0
    v_and_b32 v47, 31, v0
    v_bfe_u32 v48, v0, 4, 1
    v_bfe_u32 v49, v0, 2, 2
    v_and_b32 v50, 3, v0
    v_lshl_add_u32 v40, v46, 3, v49
    v_mul_u32_u24 v40, 0x140, v40
    v_lshl_add_u32 v40, v48, 5, v40
    v_lshl_add_u32 v40, v50, 3, v40
    v_add_u32 v8, 16384, v40
    v_add_u32 v9, 53248, v40
    v_add_u32 v10, 90112, v40
    v_add_u32 v11, 126976, v40
    v_bfe_u32 v41, v47, 1, 3
    v_xor_b32 v41, v41, v46
    v_lshlrev_b32 v41, 4, v41
    v_lshl_add_u32 v41, v47, 7, v41
    s_lshl_b32 s52, s48, 12
    v_add_u32 v41, s52, v41
    v_xor_b32 v42, 0, v41
    v_add_u32 v12, 0, v42
    v_add_u32 v16, 36864, v42
    v_add_u32 v20, 73728, v42
    v_add_u32 v24, 110592, v42
    v_xor_b32 v42, 32, v41
    v_add_u32 v13, 0, v42
    v_add_u32 v17, 36864, v42
    v_add_u32 v21, 73728, v42
    v_add_u32 v25, 110592, v42
    v_xor_b32 v42, 64, v41
    v_add_u32 v14, 0, v42
    v_add_u32 v18, 36864, v42
    v_add_u32 v22, 73728, v42
    v_add_u32 v26, 110592, v42
    v_xor_b32 v42, 96, v41
    v_add_u32 v15, 0, v42
    v_add_u32 v19, 36864, v42
    v_add_u32 v23, 73728, v42
    v_add_u32 v27, 110592, v42
    v_mov_b32 v128, 0
    v_mov_b32 v129, 0
    v_mov_b32 v130, 0
    v_mov_b32 v131, 0
    v_mov_b32 v132, 0
    v_mov_b32 v133, 0
    v_mov_b32 v134, 0
    v_mov_b32 v135, 0
    v_mov_b32 v136, 0
    v_mov_b32 v137, 0
    v_mov_b32 v138, 0
    v_mov_b32 v139, 0
    v_mov_b32 v140, 0
    v_mov_b32 v141, 0
    v_mov_b32 v142, 0
    v_mov_b32 v143, 0
    v_mov_b32 v144, 0
    v_mov_b32 v145, 0
    v_mov_b32 v146, 0
    v_mov_b32 v147, 0
    v_mov_b32 v148, 0
    v_mov_b32 v149, 0
    v_mov_b32 v150, 0
    v_mov_b32 v151, 0
    v_mov_b32 v152, 0
    v_mov_b32 v153, 0
    v_mov_b32 v154, 0
    v_mov_b32 v155, 0
    v_mov_b32 v156, 0
    v_mov_b32 v157, 0
    v_mov_b32 v158, 0
    v_mov_b32 v159, 0
    v_mov_b32 v160, 0
    v_mov_b32 v161, 0
    v_mov_b32 v162, 0
    v_mov_b32 v163, 0
    v_mov_b32 v164, 0
    v_mov_b32 v165, 0
    v_mov_b32 v166, 0
    v_mov_b32 v167, 0
    v_mov_b32 v168, 0
    v_mov_b32 v169, 0
    v_mov_b32 v170, 0
    v_mov_b32 v171, 0
    v_mov_b32 v172, 0
    v_mov_b32 v173, 0
    v_mov_b32 v174, 0
    v_mov_b32 v175, 0
    v_mov_b32 v176, 0
    v_mov_b32 v177, 0
    v_mov_b32 v178, 0
    v_mov_b32 v179, 0
    v_mov_b32 v180, 0
    v_mov_b32 v181, 0
    v_mov_b32 v182, 0
    v_mov_b32 v183, 0
    v_mov_b32 v184, 0
    v_mov_b32 v185, 0
    v_mov_b32 v186, 0
    v_mov_b32 v187, 0
    v_mov_b32 v188, 0
    v_mov_b32 v189, 0
    v_mov_b32 v190, 0
    v_mov_b32 v191, 0
    v_mov_b32 v192, 0
    v_mov_b32 v193, 0
    v_mov_b32 v194, 0
    v_mov_b32 v195, 0
    v_mov_b32 v196, 0
    v_mov_b32 v197, 0
    v_mov_b32 v198, 0
    v_mov_b32 v199, 0
    v_mov_b32 v200, 0
    v_mov_b32 v201, 0
    v_mov_b32 v202, 0
    v_mov_b32 v203, 0
    v_mov_b32 v204, 0
    v_mov_b32 v205, 0
    v_mov_b32 v206, 0
    v_mov_b32 v207, 0
    s_mov_b32 s61, 0
    s_waitcnt vmcnt(9)
    s_barrier
    ds_read_b128 v[32:35], v12
    ds_read_b64_tr_b16 v[64:65], v8 offset:0
    ds_read_b64_tr_b16 v[66:67], v8 offset:1280
    s_add_u32 m0, s49, 73728
    s_nop 0
    buffer_load_dwordx4 v1, s[28:31], s53 offen lds
    ds_read_b64_tr_b16 v[68:69], v8 offset:64
    ds_read_b64_tr_b16 v[70:71], v8 offset:1344
    buffer_load_dwordx4 v1, s[28:31], s53 offen offset:1024 lds
    ds_read_b64_tr_b16 v[72:73], v8 offset:128
    ds_read_b64_tr_b16 v[74:75], v8 offset:1408
    buffer_load_dwordx4 v1, s[28:31], s53 offen offset:2048 lds
    ds_read_b64_tr_b16 v[76:77], v8 offset:192
    ds_read_b64_tr_b16 v[78:79], v8 offset:1472
    buffer_load_dwordx4 v1, s[28:31], s53 offen offset:3072 lds
    s_add_u32 s53, s53, 16384
    ds_read_b64_tr_b16 v[80:81], v8 offset:256
    ds_read_b64_tr_b16 v[82:83], v8 offset:1536
    s_add_u32 m0, s50, 73728
    s_nop 0
    buffer_load_dwordx4 v2, s[32:35], s54 offen lds
    ds_read_b128 v[36:39], v13
    ds_read_b64_tr_b16 v[84:85], v8 offset:5120
    ds_read_b64_tr_b16 v[86:87], v8 offset:6400
    buffer_load_dwordx4 v3, s[32:35], s54 offen offset:1024 lds
    ds_read_b64_tr_b16 v[88:89], v8 offset:5184
    ds_read_b64_tr_b16 v[90:91], v8 offset:6464
    buffer_load_dwordx4 v4, s[32:35], s54 offen offset:2048 lds
    buffer_load_dwordx4 v5, s[32:35], s54 offen offset:3072 lds
    s_add_u32 m0, s50, 77824
    s_nop 0
    buffer_load_dwordx4 v6, s[32:35], s54 offen lds
    s_add_u32 s54, s54, 81920
oproj_loop:
    s_waitcnt lgkmcnt(13)
    v_mfma_f32_32x32x16_bf16 v[128:143], v[64:67], v[32:35], v[128:143]
    ds_read_b64_tr_b16 v[92:93], v8 offset:5248
    ds_read_b64_tr_b16 v[94:95], v8 offset:6528
    s_waitcnt lgkmcnt(13)
    v_mfma_f32_32x32x16_bf16 v[144:159], v[68:71], v[32:35], v[144:159]
    ds_read_b64_tr_b16 v[64:65], v8 offset:5312
    ds_read_b64_tr_b16 v[66:67], v8 offset:6592
    s_waitcnt lgkmcnt(13)
    v_mfma_f32_32x32x16_bf16 v[160:175], v[72:75], v[32:35], v[160:175]
    ds_read_b64_tr_b16 v[68:69], v8 offset:5376
    ds_read_b64_tr_b16 v[70:71], v8 offset:6656
    s_waitcnt lgkmcnt(13)
    v_mfma_f32_32x32x16_bf16 v[176:191], v[76:79], v[32:35], v[176:191]
    ds_read_b128 v[40:43], v14
    ds_read_b64_tr_b16 v[72:73], v8 offset:10240
    ds_read_b64_tr_b16 v[74:75], v8 offset:11520
    s_waitcnt lgkmcnt(14)
    v_mfma_f32_32x32x16_bf16 v[192:207], v[80:83], v[32:35], v[192:207]
    ds_read_b64_tr_b16 v[76:77], v8 offset:10304
    ds_read_b64_tr_b16 v[78:79], v8 offset:11584
    s_waitcnt lgkmcnt(13)
    v_mfma_f32_32x32x16_bf16 v[128:143], v[84:87], v[36:39], v[128:143]
    ds_read_b64_tr_b16 v[80:81], v8 offset:10368
    ds_read_b64_tr_b16 v[82:83], v8 offset:11648
    s_waitcnt lgkmcnt(13)
    v_mfma_f32_32x32x16_bf16 v[144:159], v[88:91], v[36:39], v[144:159]
    ds_read_b64_tr_b16 v[84:85], v8 offset:10432
    ds_read_b64_tr_b16 v[86:87], v8 offset:11712
    s_waitcnt lgkmcnt(13)
    v_mfma_f32_32x32x16_bf16 v[160:175], v[92:95], v[36:39], v[160:175]
    ds_read_b64_tr_b16 v[88:89], v8 offset:10496
    ds_read_b64_tr_b16 v[90:91], v8 offset:11776
    s_waitcnt lgkmcnt(13)
    v_mfma_f32_32x32x16_bf16 v[176:191], v[64:67], v[36:39], v[176:191]
    ds_read_b128 v[44:47], v15
    ds_read_b64_tr_b16 v[92:93], v8 offset:15360
    ds_read_b64_tr_b16 v[94:95], v8 offset:16640
    s_waitcnt lgkmcnt(14)
    v_mfma_f32_32x32x16_bf16 v[192:207], v[68:71], v[36:39], v[192:207]
    ds_read_b64_tr_b16 v[64:65], v8 offset:15424
    ds_read_b64_tr_b16 v[66:67], v8 offset:16704
    s_waitcnt lgkmcnt(13)
    v_mfma_f32_32x32x16_bf16 v[128:143], v[72:75], v[40:43], v[128:143]
    ds_read_b64_tr_b16 v[68:69], v8 offset:15488
    ds_read_b64_tr_b16 v[70:71], v8 offset:16768
    s_waitcnt lgkmcnt(13)
    v_mfma_f32_32x32x16_bf16 v[144:159], v[76:79], v[40:43], v[144:159]
    ds_read_b64_tr_b16 v[72:73], v8 offset:15552
    ds_read_b64_tr_b16 v[74:75], v8 offset:16832
    s_waitcnt lgkmcnt(13)
    v_mfma_f32_32x32x16_bf16 v[160:175], v[80:83], v[40:43], v[160:175]
    ds_read_b64_tr_b16 v[76:77], v8 offset:15616
    ds_read_b64_tr_b16 v[78:79], v8 offset:16896
    s_waitcnt lgkmcnt(13)
    v_mfma_f32_32x32x16_bf16 v[176:191], v[84:87], v[40:43], v[176:191]
    s_waitcnt vmcnt(9)
    s_barrier
    ds_read_b128 v[48:51], v16
    ds_read_b64_tr_b16 v[80:81], v9 offset:0
    ds_read_b64_tr_b16 v[82:83], v9 offset:1280
    s_add_u32 m0, s49, 110592
    s_nop 0
    buffer_load_dwordx4 v1, s[28:31], s53 offen lds
    s_waitcnt lgkmcnt(14)
    v_mfma_f32_32x32x16_bf16 v[192:207], v[88:91], v[40:43], v[192:207]
    ds_read_b64_tr_b16 v[84:85], v9 offset:64
    ds_read_b64_tr_b16 v[86:87], v9 offset:1344
    buffer_load_dwordx4 v1, s[28:31], s53 offen offset:1024 lds
    s_waitcnt lgkmcnt(13)
    v_mfma_f32_32x32x16_bf16 v[128:143], v[92:95], v[44:47], v[128:143]
    ds_read_b64_tr_b16 v[88:89], v9 offset:128
    ds_read_b64_tr_b16 v[90:91], v9 offset:1408
    buffer_load_dwordx4 v1, s[28:31], s53 offen offset:2048 lds
    s_waitcnt lgkmcnt(13)
    v_mfma_f32_32x32x16_bf16 v[144:159], v[64:67], v[44:47], v[144:159]
    ds_read_b64_tr_b16 v[92:93], v9 offset:192
    ds_read_b64_tr_b16 v[94:95], v9 offset:1472
    buffer_load_dwordx4 v1, s[28:31], s53 offen offset:3072 lds
    s_add_u32 s53, s53, 16384
    s_waitcnt lgkmcnt(13)
    v_mfma_f32_32x32x16_bf16 v[160:175], v[68:71], v[44:47], v[160:175]
    ds_read_b64_tr_b16 v[64:65], v9 offset:256
    ds_read_b64_tr_b16 v[66:67], v9 offset:1536
    s_add_u32 m0, s50, 110592
    s_nop 0
    buffer_load_dwordx4 v2, s[32:35], s54 offen lds
    s_waitcnt lgkmcnt(13)
    v_mfma_f32_32x32x16_bf16 v[176:191], v[72:75], v[44:47], v[176:191]
    ds_read_b128 v[52:55], v17
    ds_read_b64_tr_b16 v[68:69], v9 offset:5120
    ds_read_b64_tr_b16 v[70:71], v9 offset:6400
    buffer_load_dwordx4 v3, s[32:35], s54 offen offset:1024 lds
    s_waitcnt lgkmcnt(14)
    v_mfma_f32_32x32x16_bf16 v[192:207], v[76:79], v[44:47], v[192:207]
    ds_read_b64_tr_b16 v[72:73], v9 offset:5184
    ds_read_b64_tr_b16 v[74:75], v9 offset:6464
    buffer_load_dwordx4 v4, s[32:35], s54 offen offset:2048 lds
    s_waitcnt lgkmcnt(13)
    v_mfma_f32_32x32x16_bf16 v[128:143], v[80:83], v[48:51], v[128:143]
    ds_read_b64_tr_b16 v[76:77], v9 offset:5248
    ds_read_b64_tr_b16 v[78:79], v9 offset:6528
    buffer_load_dwordx4 v5, s[32:35], s54 offen offset:3072 lds
    s_waitcnt lgkmcnt(13)
    v_mfma_f32_32x32x16_bf16 v[144:159], v[84:87], v[48:51], v[144:159]
    ds_read_b64_tr_b16 v[80:81], v9 offset:5312
    ds_read_b64_tr_b16 v[82:83], v9 offset:6592
    s_add_u32 m0, s50, 114688
    s_nop 0
    buffer_load_dwordx4 v6, s[32:35], s54 offen lds
    s_add_u32 s54, s54, 81920
    s_waitcnt lgkmcnt(13)
    v_mfma_f32_32x32x16_bf16 v[160:175], v[88:91], v[48:51], v[160:175]
    ds_read_b64_tr_b16 v[84:85], v9 offset:5376
    ds_read_b64_tr_b16 v[86:87], v9 offset:6656
    s_waitcnt lgkmcnt(13)
    v_mfma_f32_32x32x16_bf16 v[176:191], v[92:95], v[48:51], v[176:191]
    ds_read_b128 v[56:59], v18
    ds_read_b64_tr_b16 v[88:89], v9 offset:10240
    ds_read_b64_tr_b16 v[90:91], v9 offset:11520
    s_waitcnt lgkmcnt(14)
    v_mfma_f32_32x32x16_bf16 v[192:207], v[64:67], v[48:51], v[192:207]
    ds_read_b64_tr_b16 v[92:93], v9 offset:10304
    ds_read_b64_tr_b16 v[94:95], v9 offset:11584
    s_waitcnt lgkmcnt(13)
    v_mfma_f32_32x32x16_bf16 v[128:143], v[68:71], v[52:55], v[128:143]
    ds_read_b64_tr_b16 v[64:65], v9 offset:10368
    ds_read_b64_tr_b16 v[66:67], v9 offset:11648
    s_waitcnt lgkmcnt(13)
    v_mfma_f32_32x32x16_bf16 v[144:159], v[72:75], v[52:55], v[144:159]
    ds_read_b64_tr_b16 v[68:69], v9 offset:10432
    ds_read_b64_tr_b16 v[70:71], v9 offset:11712
    s_waitcnt lgkmcnt(13)
    v_mfma_f32_32x32x16_bf16 v[160:175], v[76:79], v[52:55], v[160:175]
    ds_read_b64_tr_b16 v[72:73], v9 offset:10496
    ds_read_b64_tr_b16 v[74:75], v9 offset:11776
    s_waitcnt lgkmcnt(13)
    v_mfma_f32_32x32x16_bf16 v[176:191], v[80:83], v[52:55], v[176:191]
    ds_read_b128 v[60:63], v19
    ds_read_b64_tr_b16 v[76:77], v9 offset:15360
    ds_read_b64_tr_b16 v[78:79], v9 offset:16640
    s_waitcnt lgkmcnt(14)
    v_mfma_f32_32x32x16_bf16 v[192:207], v[84:87], v[52:55], v[192:207]
    ds_read_b64_tr_b16 v[80:81], v9 offset:15424
    ds_read_b64_tr_b16 v[82:83], v9 offset:16704
    s_waitcnt lgkmcnt(13)
    v_mfma_f32_32x32x16_bf16 v[128:143], v[88:91], v[56:59], v[128:143]
    ds_read_b64_tr_b16 v[84:85], v9 offset:15488
    ds_read_b64_tr_b16 v[86:87], v9 offset:16768
    s_waitcnt lgkmcnt(13)
    v_mfma_f32_32x32x16_bf16 v[144:159], v[92:95], v[56:59], v[144:159]
    ds_read_b64_tr_b16 v[88:89], v9 offset:15552
    ds_read_b64_tr_b16 v[90:91], v9 offset:16832
    s_waitcnt lgkmcnt(13)
    v_mfma_f32_32x32x16_bf16 v[160:175], v[64:67], v[56:59], v[160:175]
    ds_read_b64_tr_b16 v[92:93], v9 offset:15616
    ds_read_b64_tr_b16 v[94:95], v9 offset:16896
    s_waitcnt lgkmcnt(13)
    v_mfma_f32_32x32x16_bf16 v[176:191], v[68:71], v[56:59], v[176:191]
    s_waitcnt vmcnt(9)
    s_barrier
    ds_read_b128 v[32:35], v20
    ds_read_b64_tr_b16 v[64:65], v10 offset:0
    ds_read_b64_tr_b16 v[66:67], v10 offset:1280
    s_add_u32 m0, s49, 0
    s_nop 0
    buffer_load_dwordx4 v1, s[28:31], s53 offen lds
    s_waitcnt lgkmcnt(14)
    v_mfma_f32_32x32x16_bf16 v[192:207], v[72:75], v[56:59], v[192:207]
    ds_read_b64_tr_b16 v[68:69], v10 offset:64
    ds_read_b64_tr_b16 v[70:71], v10 offset:1344
    buffer_load_dwordx4 v1, s[28:31], s53 offen offset:1024 lds
    s_waitcnt lgkmcnt(13)
    v_mfma_f32_32x32x16_bf16 v[128:143], v[76:79], v[60:63], v[128:143]
    ds_read_b64_tr_b16 v[72:73], v10 offset:128
    ds_read_b64_tr_b16 v[74:75], v10 offset:1408
    buffer_load_dwordx4 v1, s[28:31], s53 offen offset:2048 lds
    s_waitcnt lgkmcnt(13)
    v_mfma_f32_32x32x16_bf16 v[144:159], v[80:83], v[60:63], v[144:159]
    ds_read_b64_tr_b16 v[76:77], v10 offset:192
    ds_read_b64_tr_b16 v[78:79], v10 offset:1472
    buffer_load_dwordx4 v1, s[28:31], s53 offen offset:3072 lds
    s_add_u32 s53, s53, 16384
    s_waitcnt lgkmcnt(13)
    v_mfma_f32_32x32x16_bf16 v[160:175], v[84:87], v[60:63], v[160:175]
    ds_read_b64_tr_b16 v[80:81], v10 offset:256
    ds_read_b64_tr_b16 v[82:83], v10 offset:1536
    s_add_u32 m0, s50, 0
    s_nop 0
    buffer_load_dwordx4 v2, s[32:35], s54 offen lds
    s_waitcnt lgkmcnt(13)
    v_mfma_f32_32x32x16_bf16 v[176:191], v[88:91], v[60:63], v[176:191]
    ds_read_b128 v[36:39], v21
    ds_read_b64_tr_b16 v[84:85], v10 offset:5120
    ds_read_b64_tr_b16 v[86:87], v10 offset:6400
    buffer_load_dwordx4 v3, s[32:35], s54 offen offset:1024 lds
    s_waitcnt lgkmcnt(14)
    v_mfma_f32_32x32x16_bf16 v[192:207], v[92:95], v[60:63], v[192:207]
    ds_read_b64_tr_b16 v[88:89], v10 offset:5184
    ds_read_b64_tr_b16 v[90:91], v10 offset:6464
    buffer_load_dwordx4 v4, s[32:35], s54 offen offset:2048 lds
    s_waitcnt lgkmcnt(13)
    v_mfma_f32_32x32x16_bf16 v[128:143], v[64:67], v[32:35], v[128:143]
    ds_read_b64_tr_b16 v[92:93], v10 offset:5248
    ds_read_b64_tr_b16 v[94:95], v10 offset:6528
    buffer_load_dwordx4 v5, s[32:35], s54 offen offset:3072 lds
    s_waitcnt lgkmcnt(13)
    v_mfma_f32_32x32x16_bf16 v[144:159], v[68:71], v[32:35], v[144:159]
    ds_read_b64_tr_b16 v[64:65], v10 offset:5312
    ds_read_b64_tr_b16 v[66:67], v10 offset:6592
    s_add_u32 m0, s50, 4096
    s_nop 0
    buffer_load_dwordx4 v6, s[32:35], s54 offen lds
    s_add_u32 s54, s54, 81920
    s_waitcnt lgkmcnt(13)
    v_mfma_f32_32x32x16_bf16 v[160:175], v[72:75], v[32:35], v[160:175]
    ds_read_b64_tr_b16 v[68:69], v10 offset:5376
    ds_read_b64_tr_b16 v[70:71], v10 offset:6656
    s_waitcnt lgkmcnt(13)
    v_mfma_f32_32x32x16_bf16 v[176:191], v[76:79], v[32:35], v[176:191]
    ds_read_b128 v[40:43], v22
    ds_read_b64_tr_b16 v[72:73], v10 offset:10240
    ds_read_b64_tr_b16 v[74:75], v10 offset:11520
    s_waitcnt lgkmcnt(14)
    v_mfma_f32_32x32x16_bf16 v[192:207], v[80:83], v[32:35], v[192:207]
    ds_read_b64_tr_b16 v[76:77], v10 offset:10304
    ds_read_b64_tr_b16 v[78:79], v10 offset:11584
    s_waitcnt lgkmcnt(13)
    v_mfma_f32_32x32x16_bf16 v[128:143], v[84:87], v[36:39], v[128:143]
    ds_read_b64_tr_b16 v[80:81], v10 offset:10368
    ds_read_b64_tr_b16 v[82:83], v10 offset:11648
    s_waitcnt lgkmcnt(13)
    v_mfma_f32_32x32x16_bf16 v[144:159], v[88:91], v[36:39], v[144:159]
    ds_read_b64_tr_b16 v[84:85], v10 offset:10432
    ds_read_b64_tr_b16 v[86:87], v10 offset:11712
    s_waitcnt lgkmcnt(13)
    v_mfma_f32_32x32x16_bf16 v[160:175], v[92:95], v[36:39], v[160:175]
    ds_read_b64_tr_b16 v[88:89], v10 offset:10496
    ds_read_b64_tr_b16 v[90:91], v10 offset:11776
    s_waitcnt lgkmcnt(13)
    v_mfma_f32_32x32x16_bf16 v[176:191], v[64:67], v[36:39], v[176:191]
    ds_read_b128 v[44:47], v23
    ds_read_b64_tr_b16 v[92:93], v10 offset:15360
    ds_read_b64_tr_b16 v[94:95], v10 offset:16640
    s_waitcnt lgkmcnt(14)
    v_mfma_f32_32x32x16_bf16 v[192:207], v[68:71], v[36:39], v[192:207]
    ds_read_b64_tr_b16 v[64:65], v10 offset:15424
    ds_read_b64_tr_b16 v[66:67], v10 offset:16704
    s_waitcnt lgkmcnt(13)
    v_mfma_f32_32x32x16_bf16 v[128:143], v[72:75], v[40:43], v[128:143]
    ds_read_b64_tr_b16 v[68:69], v10 offset:15488
    ds_read_b64_tr_b16 v[70:71], v10 offset:16768
    s_waitcnt lgkmcnt(13)
    v_mfma_f32_32x32x16_bf16 v[144:159], v[76:79], v[40:43], v[144:159]
    ds_read_b64_tr_b16 v[72:73], v10 offset:15552
    ds_read_b64_tr_b16 v[74:75], v10 offset:16832
    s_waitcnt lgkmcnt(13)
    v_mfma_f32_32x32x16_bf16 v[160:175], v[80:83], v[40:43], v[160:175]
    ds_read_b64_tr_b16 v[76:77], v10 offset:15616
    ds_read_b64_tr_b16 v[78:79], v10 offset:16896
    s_waitcnt lgkmcnt(13)
    v_mfma_f32_32x32x16_bf16 v[176:191], v[84:87], v[40:43], v[176:191]
    s_waitcnt vmcnt(9)
    s_barrier
    ds_read_b128 v[48:51], v24
    ds_read_b64_tr_b16 v[80:81], v11 offset:0
    ds_read_b64_tr_b16 v[82:83], v11 offset:1280
    s_add_u32 m0, s49, 36864
    s_nop 0
    buffer_load_dwordx4 v1, s[28:31], s53 offen lds
    s_waitcnt lgkmcnt(14)
    v_mfma_f32_32x32x16_bf16 v[192:207], v[88:91], v[40:43], v[192:207]
    ds_read_b64_tr_b16 v[84:85], v11 offset:64
    ds_read_b64_tr_b16 v[86:87], v11 offset:1344
    buffer_load_dwordx4 v1, s[28:31], s53 offen offset:1024 lds
    s_waitcnt lgkmcnt(13)
    v_mfma_f32_32x32x16_bf16 v[128:143], v[92:95], v[44:47], v[128:143]
    ds_read_b64_tr_b16 v[88:89], v11 offset:128
    ds_read_b64_tr_b16 v[90:91], v11 offset:1408
    buffer_load_dwordx4 v1, s[28:31], s53 offen offset:2048 lds
    s_waitcnt lgkmcnt(13)
    v_mfma_f32_32x32x16_bf16 v[144:159], v[64:67], v[44:47], v[144:159]
    ds_read_b64_tr_b16 v[92:93], v11 offset:192
    ds_read_b64_tr_b16 v[94:95], v11 offset:1472
    buffer_load_dwordx4 v1, s[28:31], s53 offen offset:3072 lds
    s_add_u32 s53, s53, 16384
    s_waitcnt lgkmcnt(13)
    v_mfma_f32_32x32x16_bf16 v[160:175], v[68:71], v[44:47], v[160:175]
    ds_read_b64_tr_b16 v[64:65], v11 offset:256
    ds_read_b64_tr_b16 v[66:67], v11 offset:1536
    s_add_u32 m0, s50, 36864
    s_nop 0
    buffer_load_dwordx4 v2, s[32:35], s54 offen lds
    s_waitcnt lgkmcnt(13)
    v_mfma_f32_32x32x16_bf16 v[176:191], v[72:75], v[44:47], v[176:191]
    ds_read_b128 v[52:55], v25
    ds_read_b64_tr_b16 v[68:69], v11 offset:5120
    ds_read_b64_tr_b16 v[70:71], v11 offset:6400
    buffer_load_dwordx4 v3, s[32:35], s54 offen offset:1024 lds
    s_waitcnt lgkmcnt(14)
    v_mfma_f32_32x32x16_bf16 v[192:207], v[76:79], v[44:47], v[192:207]
    ds_read_b64_tr_b16 v[72:73], v11 offset:5184
    ds_read_b64_tr_b16 v[74:75], v11 offset:6464
    buffer_load_dwordx4 v4, s[32:35], s54 offen offset:2048 lds
    s_waitcnt lgkmcnt(13)
    v_mfma_f32_32x32x16_bf16 v[128:143], v[80:83], v[48:51], v[128:143]
    ds_read_b64_tr_b16 v[76:77], v11 offset:5248
    ds_read_b64_tr_b16 v[78:79], v11 offset:6528
    buffer_load_dwordx4 v5, s[32:35], s54 offen offset:3072 lds
    s_waitcnt lgkmcnt(13)
    v_mfma_f32_32x32x16_bf16 v[144:159], v[84:87], v[48:51], v[144:159]
    ds_read_b64_tr_b16 v[80:81], v11 offset:5312
    ds_read_b64_tr_b16 v[82:83], v11 offset:6592
    s_add_u32 m0, s50, 40960
    s_nop 0
    buffer_load_dwordx4 v6, s[32:35], s54 offen lds
    s_add_u32 s54, s54, 81920
    s_waitcnt lgkmcnt(13)
    v_mfma_f32_32x32x16_bf16 v[160:175], v[88:91], v[48:51], v[160:175]
    ds_read_b64_tr_b16 v[84:85], v11 offset:5376
    ds_read_b64_tr_b16 v[86:87], v11 offset:6656
    s_waitcnt lgkmcnt(13)
    v_mfma_f32_32x32x16_bf16 v[176:191], v[92:95], v[48:51], v[176:191]
    ds_read_b128 v[56:59], v26
    ds_read_b64_tr_b16 v[88:89], v11 offset:10240
    ds_read_b64_tr_b16 v[90:91], v11 offset:11520
    s_waitcnt lgkmcnt(14)
    v_mfma_f32_32x32x16_bf16 v[192:207], v[64:67], v[48:51], v[192:207]
    ds_read_b64_tr_b16 v[92:93], v11 offset:10304
    ds_read_b64_tr_b16 v[94:95], v11 offset:11584
    s_waitcnt lgkmcnt(13)
    v_mfma_f32_32x32x16_bf16 v[128:143], v[68:71], v[52:55], v[128:143]
    ds_read_b64_tr_b16 v[64:65], v11 offset:10368
    ds_read_b64_tr_b16 v[66:67], v11 offset:11648
    s_waitcnt lgkmcnt(13)
    v_mfma_f32_32x32x16_bf16 v[144:159], v[72:75], v[52:55], v[144:159]
    ds_read_b64_tr_b16 v[68:69], v11 offset:10432
    ds_read_b64_tr_b16 v[70:71], v11 offset:11712
    s_waitcnt lgkmcnt(13)
    v_mfma_f32_32x32x16_bf16 v[160:175], v[76:79], v[52:55], v[160:175]
    ds_read_b64_tr_b16 v[72:73], v11 offset:10496
    ds_read_b64_tr_b16 v[74:75], v11 offset:11776
    s_waitcnt lgkmcnt(13)
    v_mfma_f32_32x32x16_bf16 v[176:191], v[80:83], v[52:55], v[176:191]
    ds_read_b128 v[60:63], v27
    ds_read_b64_tr_b16 v[76:77], v11 offset:15360
    ds_read_b64_tr_b16 v[78:79], v11 offset:16640
    s_waitcnt lgkmcnt(14)
    v_mfma_f32_32x32x16_bf16 v[192:207], v[84:87], v[52:55], v[192:207]
    ds_read_b64_tr_b16 v[80:81], v11 offset:15424
    ds_read_b64_tr_b16 v[82:83], v11 offset:16704
    s_waitcnt lgkmcnt(13)
    v_mfma_f32_32x32x16_bf16 v[128:143], v[88:91], v[56:59], v[128:143]
    ds_read_b64_tr_b16 v[84:85], v11 offset:15488
    ds_read_b64_tr_b16 v[86:87], v11 offset:16768
    s_waitcnt lgkmcnt(13)
    v_mfma_f32_32x32x16_bf16 v[144:159], v[92:95], v[56:59], v[144:159]
    ds_read_b64_tr_b16 v[88:89], v11 offset:15552
    ds_read_b64_tr_b16 v[90:91], v11 offset:16832
    s_waitcnt lgkmcnt(13)
    v_mfma_f32_32x32x16_bf16 v[160:175], v[64:67], v[56:59], v[160:175]
    ds_read_b64_tr_b16 v[92:93], v11 offset:15616
    ds_read_b64_tr_b16 v[94:95], v11 offset:16896
    s_waitcnt lgkmcnt(13)
    v_mfma_f32_32x32x16_bf16 v[176:191], v[68:71], v[56:59], v[176:191]
    s_waitcnt vmcnt(9)
    s_barrier
    ds_read_b128 v[32:35], v12
    ds_read_b64_tr_b16 v[64:65], v8 offset:0
    ds_read_b64_tr_b16 v[66:67], v8 offset:1280
    s_add_u32 m0, s49, 73728
    s_nop 0
    buffer_load_dwordx4 v1, s[28:31], s53 offen lds
    s_waitcnt lgkmcnt(14)
    v_mfma_f32_32x32x16_bf16 v[192:207], v[72:75], v[56:59], v[192:207]
    ds_read_b64_tr_b16 v[68:69], v8 offset:64
    ds_read_b64_tr_b16 v[70:71], v8 offset:1344
    buffer_load_dwordx4 v1, s[28:31], s53 offen offset:1024 lds
    s_waitcnt lgkmcnt(13)
    v_mfma_f32_32x32x16_bf16 v[128:143], v[76:79], v[60:63], v[128:143]
    ds_read_b64_tr_b16 v[72:73], v8 offset:128
    ds_read_b64_tr_b16 v[74:75], v8 offset:1408
    buffer_load_dwordx4 v1, s[28:31], s53 offen offset:2048 lds
    s_waitcnt lgkmcnt(13)
    v_mfma_f32_32x32x16_bf16 v[144:159], v[80:83], v[60:63], v[144:159]
    ds_read_b64_tr_b16 v[76:77], v8 offset:192
    ds_read_b64_tr_b16 v[78:79], v8 offset:1472
    buffer_load_dwordx4 v1, s[28:31], s53 offen offset:3072 lds
    s_add_u32 s53, s53, 16384
    s_waitcnt lgkmcnt(13)
    v_mfma_f32_32x32x16_bf16 v[160:175], v[84:87], v[60:63], v[160:175]
    ds_read_b64_tr_b16 v[80:81], v8 offset:256
    ds_read_b64_tr_b16 v[82:83], v8 offset:1536
    s_add_u32 m0, s50, 73728
    s_nop 0
    buffer_load_dwordx4 v2, s[32:35], s54 offen lds
    s_waitcnt lgkmcnt(13)
    v_mfma_f32_32x32x16_bf16 v[176:191], v[88:91], v[60:63], v[176:191]
    ds_read_b128 v[36:39], v13
    ds_read_b64_tr_b16 v[84:85], v8 offset:5120
    ds_read_b64_tr_b16 v[86:87], v8 offset:6400
    buffer_load_dwordx4 v3, s[32:35], s54 offen offset:1024 lds
    s_waitcnt lgkmcnt(14)
    v_mfma_f32_32x32x16_bf16 v[192:207], v[92:95], v[60:63], v[192:207]
    ds_read_b64_tr_b16 v[88:89], v8 offset:5184
    ds_read_b64_tr_b16 v[90:91], v8 offset:6464
    buffer_load_dwordx4 v4, s[32:35], s54 offen offset:2048 lds
    buffer_load_dwordx4 v5, s[32:35], s54 offen offset:3072 lds
    s_add_u32 m0, s50, 77824
    s_nop 0
    buffer_load_dwordx4 v6, s[32:35], s54 offen lds
    s_add_u32 s54, s54, 81920
    s_add_u32 s61, s61, 1
    s_cmp_lt_u32 s61, 5
    s_cbranch_scc1 oproj_loop
    s_waitcnt lgkmcnt(13)
    v_mfma_f32_32x32x16_bf16 v[128:143], v[64:67], v[32:35], v[128:143]
    ds_read_b64_tr_b16 v[92:93], v8 offset:5248
    ds_read_b64_tr_b16 v[94:95], v8 offset:6528
    s_waitcnt lgkmcnt(13)
    v_mfma_f32_32x32x16_bf16 v[144:159], v[68:71], v[32:35], v[144:159]
    ds_read_b64_tr_b16 v[64:65], v8 offset:5312
    ds_read_b64_tr_b16 v[66:67], v8 offset:6592
    s_waitcnt lgkmcnt(13)
    v_mfma_f32_32x32x16_bf16 v[160:175], v[72:75], v[32:35], v[160:175]
    ds_read_b64_tr_b16 v[68:69], v8 offset:5376
    ds_read_b64_tr_b16 v[70:71], v8 offset:6656
    s_waitcnt lgkmcnt(13)
    v_mfma_f32_32x32x16_bf16 v[176:191], v[76:79], v[32:35], v[176:191]
    ds_read_b128 v[40:43], v14
    ds_read_b64_tr_b16 v[72:73], v8 offset:10240
    ds_read_b64_tr_b16 v[74:75], v8 offset:11520
    s_waitcnt lgkmcnt(14)
    v_mfma_f32_32x32x16_bf16 v[192:207], v[80:83], v[32:35], v[192:207]
    ds_read_b64_tr_b16 v[76:77], v8 offset:10304
    ds_read_b64_tr_b16 v[78:79], v8 offset:11584
    s_waitcnt lgkmcnt(13)
    v_mfma_f32_32x32x16_bf16 v[128:143], v[84:87], v[36:39], v[128:143]
    ds_read_b64_tr_b16 v[80:81], v8 offset:10368
    ds_read_b64_tr_b16 v[82:83], v8 offset:11648
    s_waitcnt lgkmcnt(13)
    v_mfma_f32_32x32x16_bf16 v[144:159], v[88:91], v[36:39], v[144:159]
    ds_read_b64_tr_b16 v[84:85], v8 offset:10432
    ds_read_b64_tr_b16 v[86:87], v8 offset:11712
    s_waitcnt lgkmcnt(13)
    v_mfma_f32_32x32x16_bf16 v[160:175], v[92:95], v[36:39], v[160:175]
    ds_read_b64_tr_b16 v[88:89], v8 offset:10496
    ds_read_b64_tr_b16 v[90:91], v8 offset:11776
    s_waitcnt lgkmcnt(13)
    v_mfma_f32_32x32x16_bf16 v[176:191], v[64:67], v[36:39], v[176:191]
    ds_read_b128 v[44:47], v15
    ds_read_b64_tr_b16 v[92:93], v8 offset:15360
    ds_read_b64_tr_b16 v[94:95], v8 offset:16640
    s_waitcnt lgkmcnt(14)
    v_mfma_f32_32x32x16_bf16 v[192:207], v[68:71], v[36:39], v[192:207]
    ds_read_b64_tr_b16 v[64:65], v8 offset:15424
    ds_read_b64_tr_b16 v[66:67], v8 offset:16704
    s_waitcnt lgkmcnt(13)
    v_mfma_f32_32x32x16_bf16 v[128:143], v[72:75], v[40:43], v[128:143]
    ds_read_b64_tr_b16 v[68:69], v8 offset:15488
    ds_read_b64_tr_b16 v[70:71], v8 offset:16768
    s_waitcnt lgkmcnt(13)
    v_mfma_f32_32x32x16_bf16 v[144:159], v[76:79], v[40:43], v[144:159]
    ds_read_b64_tr_b16 v[72:73], v8 offset:15552
    ds_read_b64_tr_b16 v[74:75], v8 offset:16832
    s_waitcnt lgkmcnt(13)
    v_mfma_f32_32x32x16_bf16 v[160:175], v[80:83], v[40:43], v[160:175]
    ds_read_b64_tr_b16 v[76:77], v8 offset:15616
    ds_read_b64_tr_b16 v[78:79], v8 offset:16896
    s_waitcnt lgkmcnt(13)
    v_mfma_f32_32x32x16_bf16 v[176:191], v[84:87], v[40:43], v[176:191]
    s_waitcnt vmcnt(9)
    s_barrier
    ds_read_b128 v[48:51], v16
    ds_read_b64_tr_b16 v[80:81], v9 offset:0
    ds_read_b64_tr_b16 v[82:83], v9 offset:1280
    s_add_u32 m0, s49, 110592
    s_nop 0
    buffer_load_dwordx4 v1, s[28:31], s53 offen lds
    s_waitcnt lgkmcnt(14)
    v_mfma_f32_32x32x16_bf16 v[192:207], v[88:91], v[40:43], v[192:207]
    ds_read_b64_tr_b16 v[84:85], v9 offset:64
    ds_read_b64_tr_b16 v[86:87], v9 offset:1344
    buffer_load_dwordx4 v1, s[28:31], s53 offen offset:1024 lds
    s_waitcnt lgkmcnt(13)
    v_mfma_f32_32x32x16_bf16 v[128:143], v[92:95], v[44:47], v[128:143]
    ds_read_b64_tr_b16 v[88:89], v9 offset:128
    ds_read_b64_tr_b16 v[90:91], v9 offset:1408
    buffer_load_dwordx4 v1, s[28:31], s53 offen offset:2048 lds
    s_waitcnt lgkmcnt(13)
    v_mfma_f32_32x32x16_bf16 v[144:159], v[64:67], v[44:47], v[144:159]
    ds_read_b64_tr_b16 v[92:93], v9 offset:192
    ds_read_b64_tr_b16 v[94:95], v9 offset:1472
    buffer_load_dwordx4 v1, s[28:31], s53 offen offset:3072 lds
    s_add_u32 s53, s53, 16384
    s_waitcnt lgkmcnt(13)
    v_mfma_f32_32x32x16_bf16 v[160:175], v[68:71], v[44:47], v[160:175]
    ds_read_b64_tr_b16 v[64:65], v9 offset:256
    ds_read_b64_tr_b16 v[66:67], v9 offset:1536
    s_add_u32 m0, s50, 110592
    s_nop 0
    buffer_load_dwordx4 v2, s[32:35], s54 offen lds
    s_waitcnt lgkmcnt(13)
    v_mfma_f32_32x32x16_bf16 v[176:191], v[72:75], v[44:47], v[176:191]
    ds_read_b128 v[52:55], v17
    ds_read_b64_tr_b16 v[68:69], v9 offset:5120
    ds_read_b64_tr_b16 v[70:71], v9 offset:6400
    buffer_load_dwordx4 v3, s[32:35], s54 offen offset:1024 lds
    s_waitcnt lgkmcnt(14)
    v_mfma_f32_32x32x16_bf16 v[192:207], v[76:79], v[44:47], v[192:207]
    ds_read_b64_tr_b16 v[72:73], v9 offset:5184
    ds_read_b64_tr_b16 v[74:75], v9 offset:6464
    buffer_load_dwordx4 v4, s[32:35], s54 offen offset:2048 lds
    s_waitcnt lgkmcnt(13)
    v_mfma_f32_32x32x16_bf16 v[128:143], v[80:83], v[48:51], v[128:143]
    ds_read_b64_tr_b16 v[76:77], v9 offset:5248
    ds_read_b64_tr_b16 v[78:79], v9 offset:6528
    buffer_load_dwordx4 v5, s[32:35], s54 offen offset:3072 lds
    s_waitcnt lgkmcnt(13)
    v_mfma_f32_32x32x16_bf16 v[144:159], v[84:87], v[48:51], v[144:159]
    ds_read_b64_tr_b16 v[80:81], v9 offset:5312
    ds_read_b64_tr_b16 v[82:83], v9 offset:6592
    s_add_u32 m0, s50, 114688
    s_nop 0
    buffer_load_dwordx4 v6, s[32:35], s54 offen lds
    s_add_u32 s54, s54, 81920
    s_waitcnt lgkmcnt(13)
    v_mfma_f32_32x32x16_bf16 v[160:175], v[88:91], v[48:51], v[160:175]
    ds_read_b64_tr_b16 v[84:85], v9 offset:5376
    ds_read_b64_tr_b16 v[86:87], v9 offset:6656
    s_waitcnt lgkmcnt(13)
    v_mfma_f32_32x32x16_bf16 v[176:191], v[92:95], v[48:51], v[176:191]
    ds_read_b128 v[56:59], v18
    ds_read_b64_tr_b16 v[88:89], v9 offset:10240
    ds_read_b64_tr_b16 v[90:91], v9 offset:11520
    s_waitcnt lgkmcnt(14)
    v_mfma_f32_32x32x16_bf16 v[192:207], v[64:67], v[48:51], v[192:207]
    ds_read_b64_tr_b16 v[92:93], v9 offset:10304
    ds_read_b64_tr_b16 v[94:95], v9 offset:11584
    s_waitcnt lgkmcnt(13)
    v_mfma_f32_32x32x16_bf16 v[128:143], v[68:71], v[52:55], v[128:143]
    ds_read_b64_tr_b16 v[64:65], v9 offset:10368
    ds_read_b64_tr_b16 v[66:67], v9 offset:11648
    s_waitcnt lgkmcnt(13)
    v_mfma_f32_32x32x16_bf16 v[144:159], v[72:75], v[52:55], v[144:159]
    ds_read_b64_tr_b16 v[68:69], v9 offset:10432
    ds_read_b64_tr_b16 v[70:71], v9 offset:11712
    s_waitcnt lgkmcnt(13)
    v_mfma_f32_32x32x16_bf16 v[160:175], v[76:79], v[52:55], v[160:175]
    ds_read_b64_tr_b16 v[72:73], v9 offset:10496
    ds_read_b64_tr_b16 v[74:75], v9 offset:11776
    s_waitcnt lgkmcnt(13)
    v_mfma_f32_32x32x16_bf16 v[176:191], v[80:83], v[52:55], v[176:191]
    ds_read_b128 v[60:63], v19
    ds_read_b64_tr_b16 v[76:77], v9 offset:15360
    ds_read_b64_tr_b16 v[78:79], v9 offset:16640
    s_waitcnt lgkmcnt(14)
    v_mfma_f32_32x32x16_bf16 v[192:207], v[84:87], v[52:55], v[192:207]
    ds_read_b64_tr_b16 v[80:81], v9 offset:15424
    ds_read_b64_tr_b16 v[82:83], v9 offset:16704
    s_waitcnt lgkmcnt(13)
    v_mfma_f32_32x32x16_bf16 v[128:143], v[88:91], v[56:59], v[128:143]
    ds_read_b64_tr_b16 v[84:85], v9 offset:15488
    ds_read_b64_tr_b16 v[86:87], v9 offset:16768
    s_waitcnt lgkmcnt(13)
    v_mfma_f32_32x32x16_bf16 v[144:159], v[92:95], v[56:59], v[144:159]
    ds_read_b64_tr_b16 v[88:89], v9 offset:15552
    ds_read_b64_tr_b16 v[90:91], v9 offset:16832
    s_waitcnt lgkmcnt(13)
    v_mfma_f32_32x32x16_bf16 v[160:175], v[64:67], v[56:59], v[160:175]
    ds_read_b64_tr_b16 v[92:93], v9 offset:15616
    ds_read_b64_tr_b16 v[94:95], v9 offset:16896
    s_waitcnt lgkmcnt(13)
    v_mfma_f32_32x32x16_bf16 v[176:191], v[68:71], v[56:59], v[176:191]
    s_waitcnt vmcnt(9)
    s_barrier
    ds_read_b128 v[32:35], v20
    ds_read_b64_tr_b16 v[64:65], v10 offset:0
    ds_read_b64_tr_b16 v[66:67], v10 offset:1280
    s_waitcnt lgkmcnt(14)
    v_mfma_f32_32x32x16_bf16 v[192:207], v[72:75], v[56:59], v[192:207]
    ds_read_b64_tr_b16 v[68:69], v10 offset:64
    ds_read_b64_tr_b16 v[70:71], v10 offset:1344
    s_waitcnt lgkmcnt(13)
    v_mfma_f32_32x32x16_bf16 v[128:143], v[76:79], v[60:63], v[128:143]
    ds_read_b64_tr_b16 v[72:73], v10 offset:128
    ds_read_b64_tr_b16 v[74:75], v10 offset:1408
    s_waitcnt lgkmcnt(13)
    v_mfma_f32_32x32x16_bf16 v[144:159], v[80:83], v[60:63], v[144:159]
    ds_read_b64_tr_b16 v[76:77], v10 offset:192
    ds_read_b64_tr_b16 v[78:79], v10 offset:1472
    s_waitcnt lgkmcnt(13)
    v_mfma_f32_32x32x16_bf16 v[160:175], v[84:87], v[60:63], v[160:175]
    ds_read_b64_tr_b16 v[80:81], v10 offset:256
    ds_read_b64_tr_b16 v[82:83], v10 offset:1536
    s_waitcnt lgkmcnt(13)
    v_mfma_f32_32x32x16_bf16 v[176:191], v[88:91], v[60:63], v[176:191]
    ds_read_b128 v[36:39], v21
    ds_read_b64_tr_b16 v[84:85], v10 offset:5120
    ds_read_b64_tr_b16 v[86:87], v10 offset:6400
    s_waitcnt lgkmcnt(14)
    v_mfma_f32_32x32x16_bf16 v[192:207], v[92:95], v[60:63], v[192:207]
    ds_read_b64_tr_b16 v[88:89], v10 offset:5184
    ds_read_b64_tr_b16 v[90:91], v10 offset:6464
    s_waitcnt lgkmcnt(13)
    v_mfma_f32_32x32x16_bf16 v[128:143], v[64:67], v[32:35], v[128:143]
    ds_read_b64_tr_b16 v[92:93], v10 offset:5248
    ds_read_b64_tr_b16 v[94:95], v10 offset:6528
    s_waitcnt lgkmcnt(13)
    v_mfma_f32_32x32x16_bf16 v[144:159], v[68:71], v[32:35], v[144:159]
    ds_read_b64_tr_b16 v[64:65], v10 offset:5312
    ds_read_b64_tr_b16 v[66:67], v10 offset:6592
    s_waitcnt lgkmcnt(13)
    v_mfma_f32_32x32x16_bf16 v[160:175], v[72:75], v[32:35], v[160:175]
    ds_read_b64_tr_b16 v[68:69], v10 offset:5376
    ds_read_b64_tr_b16 v[70:71], v10 offset:6656
    s_waitcnt lgkmcnt(13)
    v_mfma_f32_32x32x16_bf16 v[176:191], v[76:79], v[32:35], v[176:191]
    ds_read_b128 v[40:43], v22
    ds_read_b64_tr_b16 v[72:73], v10 offset:10240
    ds_read_b64_tr_b16 v[74:75], v10 offset:11520
    s_waitcnt lgkmcnt(14)
    v_mfma_f32_32x32x16_bf16 v[192:207], v[80:83], v[32:35], v[192:207]
    ds_read_b64_tr_b16 v[76:77], v10 offset:10304
    ds_read_b64_tr_b16 v[78:79], v10 offset:11584
    s_waitcnt lgkmcnt(13)
    v_mfma_f32_32x32x16_bf16 v[128:143], v[84:87], v[36:39], v[128:143]
    ds_read_b64_tr_b16 v[80:81], v10 offset:10368
    ds_read_b64_tr_b16 v[82:83], v10 offset:11648
    s_waitcnt lgkmcnt(13)
    v_mfma_f32_32x32x16_bf16 v[144:159], v[88:91], v[36:39], v[144:159]
    ds_read_b64_tr_b16 v[84:85], v10 offset:10432
    ds_read_b64_tr_b16 v[86:87], v10 offset:11712
    s_waitcnt lgkmcnt(13)
    v_mfma_f32_32x32x16_bf16 v[160:175], v[92:95], v[36:39], v[160:175]
    ds_read_b64_tr_b16 v[88:89], v10 offset:10496
    ds_read_b64_tr_b16 v[90:91], v10 offset:11776
    s_waitcnt lgkmcnt(13)
    v_mfma_f32_32x32x16_bf16 v[176:191], v[64:67], v[36:39], v[176:191]
    ds_read_b128 v[44:47], v23
    ds_read_b64_tr_b16 v[92:93], v10 offset:15360
    ds_read_b64_tr_b16 v[94:95], v10 offset:16640
    s_waitcnt lgkmcnt(14)
    v_mfma_f32_32x32x16_bf16 v[192:207], v[68:71], v[36:39], v[192:207]
    ds_read_b64_tr_b16 v[64:65], v10 offset:15424
    ds_read_b64_tr_b16 v[66:67], v10 offset:16704
    s_waitcnt lgkmcnt(13)
    v_mfma_f32_32x32x16_bf16 v[128:143], v[72:75], v[40:43], v[128:143]
    ds_read_b64_tr_b16 v[68:69], v10 offset:15488
    ds_read_b64_tr_b16 v[70:71], v10 offset:16768
    s_waitcnt lgkmcnt(13)
    v_mfma_f32_32x32x16_bf16 v[144:159], v[76:79], v[40:43], v[144:159]
    ds_read_b64_tr_b16 v[72:73], v10 offset:15552
    ds_read_b64_tr_b16 v[74:75], v10 offset:16832
    s_waitcnt lgkmcnt(13)
    v_mfma_f32_32x32x16_bf16 v[160:175], v[80:83], v[40:43], v[160:175]
    ds_read_b64_tr_b16 v[76:77], v10 offset:15616
    ds_read_b64_tr_b16 v[78:79], v10 offset:16896
    s_waitcnt lgkmcnt(13)
    v_mfma_f32_32x32x16_bf16 v[176:191], v[84:87], v[40:43], v[176:191]
    s_waitcnt vmcnt(0)
    s_barrier
    ds_read_b128 v[48:51], v24
    ds_read_b64_tr_b16 v[80:81], v11 offset:0
    ds_read_b64_tr_b16 v[82:83], v11 offset:1280
    s_waitcnt lgkmcnt(14)
    v_mfma_f32_32x32x16_bf16 v[192:207], v[88:91], v[40:43], v[192:207]
    ds_read_b64_tr_b16 v[84:85], v11 offset:64
    ds_read_b64_tr_b16 v[86:87], v11 offset:1344
    s_waitcnt lgkmcnt(13)
    v_mfma_f32_32x32x16_bf16 v[128:143], v[92:95], v[44:47], v[128:143]
    ds_read_b64_tr_b16 v[88:89], v11 offset:128
    ds_read_b64_tr_b16 v[90:91], v11 offset:1408
    s_waitcnt lgkmcnt(13)
    v_mfma_f32_32x32x16_bf16 v[144:159], v[64:67], v[44:47], v[144:159]
    ds_read_b64_tr_b16 v[92:93], v11 offset:192
    ds_read_b64_tr_b16 v[94:95], v11 offset:1472
    s_waitcnt lgkmcnt(13)
    v_mfma_f32_32x32x16_bf16 v[160:175], v[68:71], v[44:47], v[160:175]
    ds_read_b64_tr_b16 v[64:65], v11 offset:256
    ds_read_b64_tr_b16 v[66:67], v11 offset:1536
    s_waitcnt lgkmcnt(13)
    v_mfma_f32_32x32x16_bf16 v[176:191], v[72:75], v[44:47], v[176:191]
    ds_read_b128 v[52:55], v25
    ds_read_b64_tr_b16 v[68:69], v11 offset:5120
    ds_read_b64_tr_b16 v[70:71], v11 offset:6400
    s_waitcnt lgkmcnt(14)
    v_mfma_f32_32x32x16_bf16 v[192:207], v[76:79], v[44:47], v[192:207]
    ds_read_b64_tr_b16 v[72:73], v11 offset:5184
    ds_read_b64_tr_b16 v[74:75], v11 offset:6464
    s_waitcnt lgkmcnt(13)
    v_mfma_f32_32x32x16_bf16 v[128:143], v[80:83], v[48:51], v[128:143]
    ds_read_b64_tr_b16 v[76:77], v11 offset:5248
    ds_read_b64_tr_b16 v[78:79], v11 offset:6528
    s_waitcnt lgkmcnt(13)
    v_mfma_f32_32x32x16_bf16 v[144:159], v[84:87], v[48:51], v[144:159]
    ds_read_b64_tr_b16 v[80:81], v11 offset:5312
    ds_read_b64_tr_b16 v[82:83], v11 offset:6592
    s_waitcnt lgkmcnt(13)
    v_mfma_f32_32x32x16_bf16 v[160:175], v[88:91], v[48:51], v[160:175]
    ds_read_b64_tr_b16 v[84:85], v11 offset:5376
    ds_read_b64_tr_b16 v[86:87], v11 offset:6656
    s_waitcnt lgkmcnt(13)
    v_mfma_f32_32x32x16_bf16 v[176:191], v[92:95], v[48:51], v[176:191]
    ds_read_b128 v[56:59], v26
    ds_read_b64_tr_b16 v[88:89], v11 offset:10240
    ds_read_b64_tr_b16 v[90:91], v11 offset:11520
    s_waitcnt lgkmcnt(14)
    v_mfma_f32_32x32x16_bf16 v[192:207], v[64:67], v[48:51], v[192:207]
    ds_read_b64_tr_b16 v[92:93], v11 offset:10304
    ds_read_b64_tr_b16 v[94:95], v11 offset:11584
    s_waitcnt lgkmcnt(13)
    v_mfma_f32_32x32x16_bf16 v[128:143], v[68:71], v[52:55], v[128:143]
    ds_read_b64_tr_b16 v[64:65], v11 offset:10368
    ds_read_b64_tr_b16 v[66:67], v11 offset:11648
    s_waitcnt lgkmcnt(13)
    v_mfma_f32_32x32x16_bf16 v[144:159], v[72:75], v[52:55], v[144:159]
    ds_read_b64_tr_b16 v[68:69], v11 offset:10432
    ds_read_b64_tr_b16 v[70:71], v11 offset:11712
    s_waitcnt lgkmcnt(13)
    v_mfma_f32_32x32x16_bf16 v[160:175], v[76:79], v[52:55], v[160:175]
    ds_read_b64_tr_b16 v[72:73], v11 offset:10496
    ds_read_b64_tr_b16 v[74:75], v11 offset:11776
    s_waitcnt lgkmcnt(13)
    v_mfma_f32_32x32x16_bf16 v[176:191], v[80:83], v[52:55], v[176:191]
    ds_read_b128 v[60:63], v27
    ds_read_b64_tr_b16 v[76:77], v11 offset:15360
    ds_read_b64_tr_b16 v[78:79], v11 offset:16640
    s_waitcnt lgkmcnt(14)
    v_mfma_f32_32x32x16_bf16 v[192:207], v[84:87], v[52:55], v[192:207]
    ds_read_b64_tr_b16 v[80:81], v11 offset:15424
    ds_read_b64_tr_b16 v[82:83], v11 offset:16704
    s_waitcnt lgkmcnt(13)
    v_mfma_f32_32x32x16_bf16 v[128:143], v[88:91], v[56:59], v[128:143]
    ds_read_b64_tr_b16 v[84:85], v11 offset:15488
    ds_read_b64_tr_b16 v[86:87], v11 offset:16768
    s_waitcnt lgkmcnt(13)
    v_mfma_f32_32x32x16_bf16 v[144:159], v[92:95], v[56:59], v[144:159]
    ds_read_b64_tr_b16 v[88:89], v11 offset:15552
    ds_read_b64_tr_b16 v[90:91], v11 offset:16832
    s_waitcnt lgkmcnt(13)
    v_mfma_f32_32x32x16_bf16 v[160:175], v[64:67], v[56:59], v[160:175]
    ds_read_b64_tr_b16 v[92:93], v11 offset:15616
    ds_read_b64_tr_b16 v[94:95], v11 offset:16896
    s_waitcnt lgkmcnt(13)
    v_mfma_f32_32x32x16_bf16 v[176:191], v[68:71], v[56:59], v[176:191]
    s_waitcnt lgkmcnt(11)
    v_mfma_f32_32x32x16_bf16 v[192:207], v[72:75], v[56:59], v[192:207]
    s_waitcnt lgkmcnt(8)
    v_mfma_f32_32x32x16_bf16 v[128:143], v[76:79], v[60:63], v[128:143]
    s_waitcnt lgkmcnt(6)
    v_mfma_f32_32x32x16_bf16 v[144:159], v[80:83], v[60:63], v[144:159]
    s_waitcnt lgkmcnt(4)
    v_mfma_f32_32x32x16_bf16 v[160:175], v[84:87], v[60:63], v[160:175]
    s_waitcnt lgkmcnt(2)
    v_mfma_f32_32x32x16_bf16 v[176:191], v[88:91], v[60:63], v[176:191]
    s_waitcnt lgkmcnt(0)
    v_mfma_f32_32x32x16_bf16 v[192:207], v[92:95], v[60:63], v[192:207]
    s_nop 7
    s_nop 7
    v_cvt_pk_bf16_f32 v32, v128, v129
    v_cvt_pk_bf16_f32 v33, v130, v131
    v_cvt_pk_bf16_f32 v34, v132, v133
    v_cvt_pk_bf16_f32 v35, v134, v135
    v_cvt_pk_bf16_f32 v36, v136, v137
    v_cvt_pk_bf16_f32 v37, v138, v139
    v_cvt_pk_bf16_f32 v38, v140, v141
    v_cvt_pk_bf16_f32 v39, v142, v143
    v_cvt_pk_bf16_f32 v40, v144, v145
    v_cvt_pk_bf16_f32 v41, v146, v147
    v_cvt_pk_bf16_f32 v42, v148, v149
    v_cvt_pk_bf16_f32 v43, v150, v151
    v_cvt_pk_bf16_f32 v44, v152, v153
    v_cvt_pk_bf16_f32 v45, v154, v155
    v_cvt_pk_bf16_f32 v46, v156, v157
    v_cvt_pk_bf16_f32 v47, v158, v159
    v_cvt_pk_bf16_f32 v48, v160, v161
    v_cvt_pk_bf16_f32 v49, v162, v163
    v_cvt_pk_bf16_f32 v50, v164, v165
    v_cvt_pk_bf16_f32 v51, v166, v167
    v_cvt_pk_bf16_f32 v52, v168, v169
    v_cvt_pk_bf16_f32 v53, v170, v171
    v_cvt_pk_bf16_f32 v54, v172, v173
    v_cvt_pk_bf16_f32 v55, v174, v175
    v_cvt_pk_bf16_f32 v56, v176, v177
    v_cvt_pk_bf16_f32 v57, v178, v179
    v_cvt_pk_bf16_f32 v58, v180, v181
    v_cvt_pk_bf16_f32 v59, v182, v183
    v_cvt_pk_bf16_f32 v60, v184, v185
    v_cvt_pk_bf16_f32 v61, v186, v187
    v_cvt_pk_bf16_f32 v62, v188, v189
    v_cvt_pk_bf16_f32 v63, v190, v191
    v_cvt_pk_bf16_f32 v64, v192, v193
    v_cvt_pk_bf16_f32 v65, v194, v195
    v_cvt_pk_bf16_f32 v66, v196, v197
    v_cvt_pk_bf16_f32 v67, v198, v199
    v_cvt_pk_bf16_f32 v68, v200, v201
    v_cvt_pk_bf16_f32 v69, v202, v203
    v_cvt_pk_bf16_f32 v70, v204, v205
    v_cvt_pk_bf16_f32 v71, v206, v207
    s_mul_i32 s52, s48, 10240
    v_lshlrev_b32 v1, 4, v0
    v_add_u32 v1, s52, v1
    s_mov_b32 s53, 0
    buffer_store_dwordx4 v[32:35], v1, s[44:47], s53 offen
    s_mov_b32 s53, 1024
    buffer_store_dwordx4 v[36:39], v1, s[44:47], s53 offen
    s_mov_b32 s53, 2048
    buffer_store_dwordx4 v[40:43], v1, s[44:47], s53 offen
    s_mov_b32 s53, 3072
    buffer_store_dwordx4 v[44:47], v1, s[44:47], s53 offen
    s_mov_b32 s53, 4096
    buffer_store_dwordx4 v[48:51], v1, s[44:47], s53 offen
    s_mov_b32 s53, 5120
    buffer_store_dwordx4 v[52:55], v1, s[44:47], s53 offen
    s_mov_b32 s53, 6144
    buffer_store_dwordx4 v[56:59], v1, s[44:47], s53 offen
    s_mov_b32 s53, 7168
    buffer_store_dwordx4 v[60:63], v1, s[44:47], s53 offen
    s_mov_b32 s53, 8192
    buffer_store_dwordx4 v[64:67], v1, s[44:47], s53 offen
    s_mov_b32 s53, 9216
    buffer_store_dwordx4 v[68:71], v1, s[44:47], s53 offen
oproj_exit:
    s_endpgm
.globl reduce_kernel
.p2align 8
.type reduce_kernel,@function
reduce_kernel:
    s_cmp_ge_u32 s2, 640
    s_cbranch_scc1 reduce_exit
    s_load_dwordx2 s[4:5], s[0:1], 80
    s_load_dwordx2 s[24:25], s[0:1], 96
    v_lshrrev_b32 v1, 6, v0
    s_nop 1
    v_readfirstlane_b32 s48, v1
    v_and_b32 v0, 63, v0
    s_mul_i32 s52, s2, 0x199a
    s_lshr_b32 s52, s52, 16
    s_mul_i32 s53, s52, 10
    s_sub_u32 s53, s2, s53
    s_mul_i32 s54, s52, 163840
    s_mul_i32 s55, s48, 10240
    s_lshl_b32 s56, s53, 10
    s_add_u32 s55, s55, s56
    v_lshlrev_b32 v1, 4, v0
    v_add_u32 v1, s55, v1
    s_lshr_b32 s56, s52, 5
    s_bfe_u32 s57, s52, 0x30002
    s_and_b32 s58, s52, 3
    s_mul_i32 s56, s56, 1280
    s_mul_i32 s58, s58, 320
    s_add_u32 s56, s56, s58
    s_lshl_b32 s58, s53, 5
    s_add_u32 s56, s56, s58
    s_lshl_b32 s57, s57, 7
    s_lshl_b32 s58, s48, 5
    s_add_u32 s57, s57, s58
    s_mul_i32 s57, s57, 2560
    s_add_u32 s56, s56, s57
    v_and_b32 v2, 31, v0
    v_mul_u32_u24 v2, 0xa00, v2
    v_lshrrev_b32 v3, 5, v0
    v_lshl_add_u32 v2, v3, 4, v2
    v_add_u32 v2, s56, v2
    s_waitcnt lgkmcnt(0)
    s_add_u32 s54, s54, 33554432
    s_add_u32 s24, s24, s54
    s_addc_u32 s25, s25, 0
    s_mov_b32 s28, s24
    s_and_b32 s29, s25, 0xffff
    s_mov_b32 s30, 163840
    s_mov_b32 s31, 0x00020000
    s_mov_b32 s32, s4
    s_and_b32 s33, s5, 0xffff
    s_mov_b32 s34, 2621440
    s_mov_b32 s35, 0x00020000
    s_mov_b32 s53, 0
    buffer_load_dwordx4 v[4:7], v1, s[28:31], s53 offen
    s_mov_b32 s53, 40960
    buffer_load_dwordx4 v[8:11], v1, s[28:31], s53 offen
    s_mov_b32 s53, 81920
    buffer_load_dwordx4 v[12:15], v1, s[28:31], s53 offen
    s_mov_b32 s53, 122880
    buffer_load_dwordx4 v[16:19], v1, s[28:31], s53 offen
    s_waitcnt vmcnt(3)
    v_lshlrev_b32 v32, 16, v4
    v_and_b32 v33, 0xffff0000, v4
    v_lshlrev_b32 v34, 16, v5
    v_and_b32 v35, 0xffff0000, v5
    v_lshlrev_b32 v36, 16, v6
    v_and_b32 v37, 0xffff0000, v6
    v_lshlrev_b32 v38, 16, v7
    v_and_b32 v39, 0xffff0000, v7
    s_waitcnt vmcnt(2)
    v_lshlrev_b32 v24, 16, v8
    v_and_b32 v25, 0xffff0000, v8
    v_pk_add_f32 v[32:33], v[32:33], v[24:25]
    v_lshlrev_b32 v24, 16, v9
    v_and_b32 v25, 0xffff0000, v9
    v_pk_add_f32 v[34:35], v[34:35], v[24:25]
    v_lshlrev_b32 v24, 16, v10
    v_and_b32 v25, 0xffff0000, v10
    v_pk_add_f32 v[36:37], v[36:37], v[24:25]
    v_lshlrev_b32 v24, 16, v11
    v_and_b32 v25, 0xffff0000, v11
    v_pk_add_f32 v[38:39], v[38:39], v[24:25]
    s_waitcnt vmcnt(1)
    v_lshlrev_b32 v24, 16, v12
    v_and_b32 v25, 0xffff0000, v12
    v_pk_add_f32 v[32:33], v[32:33], v[24:25]
    v_lshlrev_b32 v24, 16, v13
    v_and_b32 v25, 0xffff0000, v13
    v_pk_add_f32 v[34:35], v[34:35], v[24:25]
    v_lshlrev_b32 v24, 16, v14
    v_and_b32 v25, 0xffff0000, v14
    v_pk_add_f32 v[36:37], v[36:37], v[24:25]
    v_lshlrev_b32 v24, 16, v15
    v_and_b32 v25, 0xffff0000, v15
    v_pk_add_f32 v[38:39], v[38:39], v[24:25]
    s_waitcnt vmcnt(0)
    v_lshlrev_b32 v24, 16, v16
    v_and_b32 v25, 0xffff0000, v16
    v_pk_add_f32 v[32:33], v[32:33], v[24:25]
    v_lshlrev_b32 v24, 16, v17
    v_and_b32 v25, 0xffff0000, v17
    v_pk_add_f32 v[34:35], v[34:35], v[24:25]
    v_lshlrev_b32 v24, 16, v18
    v_and_b32 v25, 0xffff0000, v18
    v_pk_add_f32 v[36:37], v[36:37], v[24:25]
    v_lshlrev_b32 v24, 16, v19
    v_and_b32 v25, 0xffff0000, v19
    v_pk_add_f32 v[38:39], v[38:39], v[24:25]
    v_cvt_pk_bf16_f32 v40, v32, v33
    v_cvt_pk_bf16_f32 v41, v34, v35
    v_cvt_pk_bf16_f32 v42, v36, v37
    v_cvt_pk_bf16_f32 v43, v38, v39
    s_nop 1
    v_permlane32_swap_b32 v40, v42
    v_permlane32_swap_b32 v41, v43
    s_nop 1
    buffer_store_dwordx4 v[40:43], v2, s[32:35], 0 offen
reduce_exit:
    s_endpgm
.section .rodata,"a"
.p2align 6
.amdhsa_kernel attn_kernel
  .amdhsa_next_free_vgpr 256
  .amdhsa_next_free_sgpr 102
  .amdhsa_accum_offset 256
  .amdhsa_group_segment_fixed_size 0
  .amdhsa_kernarg_size 104
  .amdhsa_user_sgpr_count 2
  .amdhsa_user_sgpr_kernarg_segment_ptr 1
  .amdhsa_system_sgpr_workgroup_id_x 1
.end_amdhsa_kernel
.p2align 6
.amdhsa_kernel oproj_kernel
  .amdhsa_next_free_vgpr 208
  .amdhsa_next_free_sgpr 102
  .amdhsa_accum_offset 208
  .amdhsa_group_segment_fixed_size 0
  .amdhsa_kernarg_size 104
  .amdhsa_user_sgpr_count 2
  .amdhsa_user_sgpr_kernarg_segment_ptr 1
  .amdhsa_system_sgpr_workgroup_id_x 1
.end_amdhsa_kernel
.p2align 6
.amdhsa_kernel reduce_kernel
  .amdhsa_next_free_vgpr 44
  .amdhsa_next_free_sgpr 102
  .amdhsa_accum_offset 44
  .amdhsa_group_segment_fixed_size 0
  .amdhsa_kernarg_size 104
  .amdhsa_user_sgpr_count 2
  .amdhsa_user_sgpr_kernarg_segment_ptr 1
  .amdhsa_system_sgpr_workgroup_id_x 1
.end_amdhsa_kernel
```
